```python
import torch

def _softmax(x, axis=-1):
    return torch.softmax(x, dim=axis)
def _gelu(x):
    return torch.nn.functional.gelu(x, approximate="tanh")
def _silu(x):
    return torch.nn.functional.silu(x)
def _sigmoid(x):
    return torch.sigmoid(x)
def _layernorm(x, axis=-1, eps=1e-5):
    m = x.mean(dim=axis, keepdim=True)
    v = x.var(dim=axis, keepdim=True, unbiased=False)
    return (x - m) / torch.sqrt(v + eps)
def _scatter_add(tgt, idx, src, axis=0):
    return tgt.clone().index_add_(axis, idx, src)
def _segment_sum(src, seg, n):
    out = torch.zeros((n,) + src.shape[1:], dtype=src.dtype)
    return out.index_add_(0, seg, src)
def _pad(x, pw):
    flat = tuple(v for pair in reversed(pw) for v in pair)
    return torch.nn.functional.pad(x, flat)

kernel_name = 'parallel_sum__ssm_conv_s4__glu_gated_reglu__prompt'

def setup_inputs():

    _w = (lambda a: (lambda t: t.to(torch.bfloat16) if t.is_floating_point() else t)(torch.as_tensor(a)))
    def _A_setup():
        B, L, D, N = 1, 2048, 512, 128
        A_re = -(lambda _x: torch.exp(torch.as_tensor(_x)))((lambda *s: torch.randn(*s, dtype=torch.bfloat16) * 6.4)(D, N))
        A_im = torch.pi * (lambda *s: torch.randn(*s, dtype=torch.bfloat16) * 0.05)(D, N)
        B_re = (lambda *s: torch.randn(*s, dtype=torch.bfloat16) * 0.1)(D, N)
        B_im = (lambda *s: torch.randn(*s, dtype=torch.bfloat16) * 0.1)(D, N)
        C_re = (lambda *s: torch.randn(*s, dtype=torch.bfloat16) * 0.1)(D, N)
        C_im = (lambda *s: torch.randn(*s, dtype=torch.bfloat16) * 0.1)(D, N)
        log_dt = (lambda *s: torch.randn(*s, dtype=torch.bfloat16) * 0.05)(D) * 0.5 - 4.0
        Dskip = (lambda *s: torch.randn(*s, dtype=torch.bfloat16) * 0.05)(D)
        return {
            "u": _w((lambda *s: torch.randn(*s, dtype=torch.bfloat16) * 0.05)(B, L, D)),
            "A_re": _w(A_re),
            "A_im": _w(A_im),
            "B_re": _w(B_re),
            "B_im": _w(B_im),
            "C_re": _w(C_re),
            "C_im": _w(C_im),
            "log_dt": _w(log_dt),
            "Dskip": _w(Dskip),
        }
    _A_in = _A_setup()

    def _B_setup():
        B, S, D, F = 1, 2048, 512, 1792
        return {
            "x": _w((lambda *s: torch.randn(*s, dtype=torch.bfloat16) * 0.05)(B, S, D)),
            "W_gate": _w((lambda *s: torch.randn(*s, dtype=torch.bfloat16) * 0.4)(D, F) * (2.0 / D) ** 0.5),
            "W_up": _w((lambda *s: torch.randn(*s, dtype=torch.bfloat16) * 0.4)(D, F) * (2.0 / D) ** 0.5),
            "W_down": _w((lambda *s: torch.randn(*s, dtype=torch.bfloat16) * 0.4)(F, D) * (1.0 / F) ** 0.5),
        }
    _B_in = _B_setup()

    return {
        "A_u": _A_in["u"],
        "A_A_re": _A_in["A_re"],
        "A_A_im": _A_in["A_im"],
        "A_B_re": _A_in["B_re"],
        "A_B_im": _A_in["B_im"],
        "A_C_re": _A_in["C_re"],
        "A_C_im": _A_in["C_im"],
        "A_log_dt": _A_in["log_dt"],
        "A_Dskip": _A_in["Dskip"],
        "B_x": _B_in["x"],
        "B_W_gate": _B_in["W_gate"],
        "B_W_up": _B_in["W_up"],
        "B_W_down": _B_in["W_down"],
    }

def reference(A_u, A_A_re, A_A_im, A_B_re, A_B_im, A_C_re, A_C_im, A_log_dt, A_Dskip, B_x, B_W_gate, B_W_up, B_W_down):
    def _A_ref(u, A_re, A_im, B_re, B_im, C_re, C_im, log_dt, Dskip):
        Bsz, L, D = u.shape
        dt = torch.exp(log_dt)[:, None]
        A = A_re + 1j * A_im
        Bc = B_re + 1j * B_im
        Cc = C_re + 1j * C_im
        logdA = dt * A
        dB = dt * Bc
        l = (lambda x, dt: x.to(dt))(torch.arange(L), A_re.dtype)
        P = torch.exp(logdA[:, :, None] * l[None, None, :])
        K = torch.einsum("dn,dnl,dn->dl", Cc, P, dB).real
        L2 = 2 * L
        Kp = _pad(K, ((0, 0), (0, L)))
        up = (lambda x, *d: x.permute(*d))(u, 0, 2, 1)
        up = _pad(up, ((0, 0), (0, 0), (0, L)))
        Kf = (lambda x, axes=(-2,-1): torch.fft.rfft2(x.float(), dim=axes))(Kp[:, None, :], axes=(-2, -1))
        Uf = (lambda x, axes=(-2,-1): torch.fft.rfft2(x.float(), dim=axes))(up[:, :, None, :], axes=(-2, -1))
        Yf = Uf * Kf[None, :, :, :]
        y = (lambda x, s, axes=(-2,-1): torch.fft.irfft2(x, s=s, dim=axes).to(torch.bfloat16))(Yf, (1, L2), axes=(-2, -1))[:, :, 0, :L]
        y = (lambda x, *d: x.permute(*d))(y, 0, 2, 1) + u * Dskip[None, None, :]
        return y

    def _B_ref(x, W_gate, W_up, W_down):
        gate = torch.einsum("bsd,df->bsf", x, W_gate)
        up = torch.einsum("bsd,df->bsf", x, W_up)
        gate = gate * (lambda x, dt: x.to(dt))(gate > 0, gate.dtype)
        h = gate * up
        return torch.einsum("bsf,fd->bsd", h, W_down)

    x = A_u
    xn = _layernorm(x, axis=-1)
    return x + _A_ref(xn, A_A_re, A_A_im, A_B_re, A_B_im, A_C_re, A_C_im, A_log_dt, A_Dskip) + _B_ref(xn, B_W_gate, B_W_up, B_W_down)
```

```asm
; @launch grid=(256,1,1) block=(512,1,1) lds=163840
.amdgcn_target "amdgcn-amd-amdhsa--gfx950"
.text
.globl parallel_sum__ssm_conv_s4__glu_gated_reglu__prompt_kernel
.p2align 8
.type parallel_sum__ssm_conv_s4__glu_gated_reglu__prompt_kernel,@function
parallel_sum__ssm_conv_s4__glu_gated_reglu__prompt_kernel:
    s_cmp_ge_u32 s2, 256
    s_cbranch_scc1 L_end
    s_load_dwordx16 s[8:23], s[0:1], 0
    s_load_dwordx16 s[24:39], s[0:1], 64
    s_getpc_b64 s[62:63]
L_pc:
    s_lshr_b32 s60, s2, 3
    s_lshl_b32 s60, s60, 11
    v_and_b32 v2, 0x1e0, v0
    v_lshl_add_u32 v2, v2, 2, s60
    v_min_u32 v2, L_code_end-L_pc-4, v2
    global_load_dword v140, v2, s[62:63]
    v_lshrrev_b32 v2, 6, v0
    v_and_b32 v1, 63, v0
    v_readfirstlane_b32 s59, v2
    v_and_b32 v0, 255, v0
    s_and_b32 s57, s2, 7
    s_lshl_b32 s57, s57, 2
    s_lshr_b32 s57, 0x75316420, s57
    s_and_b32 s57, s57, 7
    s_lshr_b32 s58, s2, 3
    s_add_u32 s58, s58, 28
    s_and_b32 s58, s58, 31
    s_and_b32 s56, s59, 3
    s_cmp_ge_u32 s58, 28
    s_cbranch_scc1 L_spare
    s_and_b32 s60, s57, 1
    s_lshl_b32 s60, s60, 2
    s_and_b32 s61, s58, 3
    s_add_u32 s64, s60, s61
    s_lshr_b32 s60, s57, 1
    s_mul_i32 s60, s60, 7
    s_lshr_b32 s61, s58, 2
    s_add_u32 s65, s60, s61
    v_lshrrev_b32 v2, 3, v1
    v_and_b32 v3, 7, v1
    v_lshrrev_b32 v4, 4, v1
    v_xor_b32 v5, v3, v4
    v_lshlrev_b32 v5, 4, v5
    v_lshl_add_u32 v5, v2, 10, v5
    s_lshl_b32 s60, s64, 18
    s_lshl_b32 s61, s56, 16
    s_add_u32 s60, s60, s61
    v_add_u32 v5, s60, v5
    v_add_u32 v8, 0, v5
    v_add_u32 v9, 7168, v5
    v_xor_b32 v9, 64, v9
    v_add_u32 v10, 14336, v5
    v_add_u32 v11, 21504, v5
    v_xor_b32 v11, 64, v11
    v_add_u32 v12, 32768, v5
    v_add_u32 v13, 39936, v5
    v_xor_b32 v13, 64, v13
    v_add_u32 v14, 47104, v5
    v_add_u32 v15, 54272, v5
    v_xor_b32 v15, 64, v15
    s_lshr_b32 s60, s56, 2
    s_lshl_b32 s60, s60, 2
    v_bfe_u32 v4, v1, 4, 1
    v_lshl_add_u32 v4, v4, 1, s60
    v_xor_b32 v4, v3, v4
    v_lshlrev_b32 v4, 4, v4
    v_mul_u32_u24 v5, 3584, v2
    v_add_u32 v5, v5, v4
    s_and_b32 s60, s56, 1
    s_mul_i32 s60, s60, 114688
    s_lshl_b32 s61, s65, 7
    s_add_u32 s60, s60, s61
    v_add_u32 v5, s60, v5
    v_add_u32 v16, 0, v5
    v_add_u32 v17, 27648, v5
    v_xor_b32 v17, 64, v17
    v_add_u32 v18, 55296, v5
    v_add_u32 v19, 82944, v5
    v_xor_b32 v19, 64, v19
    s_add_u32 s62, s64, s65
    s_and_b32 s62, s62, 1
    s_mul_i32 s62, s62, 15
    s_sub_u32 s68, 0x76543210, s62
    s_lshl_b32 s60, s56, 13
    s_lshl_b32 s61, s56, 12
    s_add_u32 s80, s60, 0
    s_add_u32 s81, s60, 4096
    s_add_u32 s82, s61, 81920
    s_add_u32 s83, s60, 32768
    s_add_u32 s84, s60, 36864
    s_add_u32 s85, s61, 98304
    s_add_u32 s86, s60, 131072
    s_add_u32 s87, s60, 135168
    s_add_u32 s88, s61, 114688
    s_bfe_u32 s67, s68, 0x40000
    s_lshl_b32 s66, s67, 7
    s_mul_i32 s67, s67, 229376
    s_lshl_b32 s71, s57, 5
    s_add_u32 s71, s71, s58
    s_lshl_b32 s60, s71, 9
    v_lshl_add_u32 v6, v0, 1, s60
    s_cmp_ge_u32 s59, 4
    s_cbranch_scc1 L_p2
    s_mul_i32 s60, s57, 28
    s_add_u32 s60, s60, s58
    s_lshr_b32 s61, s60, 2
    s_and_b32 s60, s60, 3
    s_lshl_b32 s60, s60, 2
    s_add_u32 s60, s60, s56
    s_lshl_b32 s62, s61, 15
    s_lshl_b32 s63, s60, 6
    s_add_u32 s62, s62, s63
    s_lshl_b32 s61, s61, 1
    s_and_b32 s63, s60, 1
    s_add_u32 s61, s61, s63
    s_lshr_b32 s60, s60, 1
    s_lshl_b32 s79, s61, 3
    s_add_u32 s79, s79, s60
    s_mul_i32 s60, s60, 224
    s_add_u32 s60, s60, s61
    s_lshl_b32 s60, s60, 10
    s_add_u32 s63, s60, 0x500000
    s_lshl_b32 s77, s56, 11
    s_add_u32 s77, s77, 65536
    v_lshrrev_b32 v2, 2, v1
    v_and_b32 v3, 3, v1
    v_lshlrev_b32 v4, 3, v3
    v_lshl_add_u32 v4, v2, 6, v4
    v_add_u32 v5, s77, v4
    v_lshlrev_b32 v3, 4, v3
    v_lshl_add_u32 v4, v2, 10, v3
    v_lshlrev_b32 v3, 4, v1
L_p2:
    s_waitcnt lgkmcnt(0)
    s_load_dword s69, s[38:39], 0
    s_mov_b32 s40, s8
    s_mov_b32 s41, s9
    s_mov_b32 s42, 0x200000
    s_mov_b32 s43, 0x20000
    s_mov_b32 s48, s38
    s_mov_b32 s49, s39
    s_mov_b32 s50, 0x1000000
    s_mov_b32 s51, 0x20000
    s_cmp_lt_u32 s56, 2
    s_cselect_b32 s44, s28, s30
    s_cselect_b32 s45, s29, s31
    s_mov_b32 s46, 0x1c0000
    s_mov_b32 s47, 0x20000
    s_cmp_lt_u32 s59, 4
    s_cbranch_scc1 L_G1
    s_lshl_b32 s60, s71, 2
    s_load_dword s72, s[22:23], s60
    global_load_ushort v24, v6, s[10:11] nt
    global_load_ushort v25, v6, s[12:13] nt
    global_load_ushort v26, v6, s[14:15] nt
    global_load_ushort v27, v6, s[16:17] nt
    global_load_ushort v28, v6, s[18:19] nt
    global_load_ushort v29, v6, s[20:21] nt
    s_mov_b32 m0, s80
    s_nop 0
    buffer_load_dwordx4 v8, s[40:43], s66 offen offset:0  lds
    buffer_load_dwordx4 v9, s[40:43], s66 offen offset:1024  lds
    buffer_load_dwordx4 v10, s[40:43], s66 offen offset:2048  lds
    buffer_load_dwordx4 v11, s[40:43], s66 offen offset:3072  lds
    s_branch L_H2
L_G1:
    s_mov_b32 s52, s32
    s_mov_b32 s53, s33
    s_mov_b32 s54, 0x1c0000
    s_mov_b32 s55, 0x20000
    s_barrier
    s_mov_b32 m0, s77
    s_nop 0
    buffer_load_dwordx4 v4, s[52:55], s62 offen nt lds
    s_add_u32 m0, s77, 1024
    s_add_u32 s62, s62, 16384
    buffer_load_dwordx4 v4, s[52:55], s62 offen nt lds
    s_mov_b32 m0, s81
    s_nop 0
    buffer_load_dwordx4 v12, s[40:43], s66 offen offset:0  lds
    buffer_load_dwordx4 v13, s[40:43], s66 offen offset:1024  lds
    buffer_load_dwordx4 v14, s[40:43], s66 offen offset:2048  lds
    buffer_load_dwordx4 v15, s[40:43], s66 offen offset:3072  lds
    s_mov_b32 m0, s82
    s_nop 0
    buffer_load_dwordx4 v16, s[44:47], s67 offen offset:0  lds
    buffer_load_dwordx4 v17, s[44:47], s67 offen offset:1024  lds
    buffer_load_dwordx4 v18, s[44:47], s67 offen offset:2048  lds
    buffer_load_dwordx4 v19, s[44:47], s67 offen offset:3072  lds
    s_bfe_u32 s67, s68, 0x40004
    s_lshl_b32 s66, s67, 7
    s_mul_i32 s67, s67, 229376
    s_mov_b32 m0, s83
    s_nop 0
    buffer_load_dwordx4 v8, s[40:43], s66 offen offset:0  lds
    buffer_load_dwordx4 v9, s[40:43], s66 offen offset:1024  lds
    buffer_load_dwordx4 v10, s[40:43], s66 offen offset:2048  lds
    buffer_load_dwordx4 v11, s[40:43], s66 offen offset:3072  lds
    s_branch L_G2
L_H2:
    s_barrier
    v_and_b32 v2, 1, v1
    v_lshlrev_b32 v2, 4, v2
    v_mov_b32 v3, 0x3f80
    v_lshlrev_b32 v2, v2, v3
    v_bfe_u32 v3, v1, 1, 4
    v_lshrrev_b32 v4, 5, v1
    v_lshlrev_b32 v4, 2, v4
    v_sub_u32 v4, v3, v4
    v_cmp_gt_u32 s[62:63], 32, v1
    v_cmp_eq_u32 vcc, 0, v4
    s_nop 1
    v_cndmask_b32 v240, 0, v2, vcc
    v_cmp_eq_u32 vcc, 8, v4
    s_nop 1
    v_cndmask_b32 v244, 0, v2, vcc
    v_cmp_eq_u32 vcc, 8, v3
    s_nop 1
    v_cndmask_b32 v5, 0, v2, vcc
    v_cndmask_b32 v248, 0, v5, s[62:63]
    v_cndmask_b32 v252, v5, 0, s[62:63]
    v_cmp_eq_u32 vcc, 1, v4
    s_nop 1
    v_cndmask_b32 v241, 0, v2, vcc
    v_cmp_eq_u32 vcc, 9, v4
    s_nop 1
    v_cndmask_b32 v245, 0, v2, vcc
    v_cmp_eq_u32 vcc, 9, v3
    s_nop 1
    v_cndmask_b32 v5, 0, v2, vcc
    v_cndmask_b32 v249, 0, v5, s[62:63]
    v_cndmask_b32 v253, v5, 0, s[62:63]
    v_cmp_eq_u32 vcc, 2, v4
    s_nop 1
    v_cndmask_b32 v242, 0, v2, vcc
    v_cmp_eq_u32 vcc, 10, v4
    s_nop 1
    v_cndmask_b32 v246, 0, v2, vcc
    v_cmp_eq_u32 vcc, 10, v3
    s_nop 1
    v_cndmask_b32 v5, 0, v2, vcc
    v_cndmask_b32 v250, 0, v5, s[62:63]
    v_cndmask_b32 v254, v5, 0, s[62:63]
    v_cmp_eq_u32 vcc, 3, v4
    s_nop 1
    v_cndmask_b32 v243, 0, v2, vcc
    v_cmp_eq_u32 vcc, 11, v4
    s_nop 1
    v_cndmask_b32 v247, 0, v2, vcc
    v_cmp_eq_u32 vcc, 11, v3
    s_nop 1
    v_cndmask_b32 v5, 0, v2, vcc
    v_cndmask_b32 v251, 0, v5, s[62:63]
    v_cndmask_b32 v255, v5, 0, s[62:63]
    v_min_u32 v2, 27, v1
    v_lshrrev_b32 v3, 1, v2
    s_mul_i32 s60, s58, 28
    s_lshr_b32 s61, s56, 1
    s_mul_i32 s61, s61, 14
    s_add_u32 s60, s60, s61
    v_add_u32 v3, s60, v3
    v_min_u32 v3, 767, v3
    s_lshr_b32 s61, s57, 1
    s_lshl_b32 s60, s61, 8
    s_add_u32 s60, s60, 256
    v_add_u32 v3, s60, v3
    v_and_b32 v3, 1023, v3
    s_and_b32 s60, s57, 1
    s_lshl_b32 s60, s60, 20
    v_lshl_add_u32 v3, v3, 10, s60
    v_and_b32 v2, 1, v2
    v_lshl_add_u32 v3, v2, 7, v3
    v_and_b32 v2, 31, v1
    s_lshl_b32 s60, s58, 5
    v_add_u32 v2, s60, v2
    v_mul_u32_u24 v4, 9363, v2
    v_lshrrev_b32 v4, 16, v4
    v_mul_u32_u24 v5, 7, v4
    v_sub_u32 v2, v2, v5
    v_mul_u32_u24 v4, 3584, v4
    v_lshl_add_u32 v4, v2, 7, v4
    s_mul_i32 s61, s61, 896
    v_add_u32 v4, s61, v4
    s_add_u32 s60, s56, 1
    s_bitcmp1_b32 s60, 1
    s_cselect_b64 vcc, -1, 0
    s_mov_b32 s61, 256
    s_cselect_b32 s3, 458752, s61
    v_cndmask_b32 v53, v3, v4, vcc
    s_add_u32 s60, s56, 1
    s_bitcmp1_b32 s60, 1
    s_cselect_b32 s4, s44, s40
    s_cselect_b32 s5, s45, s41
    s_cselect_b32 s6, s46, s42
    s_mov_b32 s7, 0x20000
    s_waitcnt lgkmcnt(0)
    s_mul_i32 s69, s69, 0x9e3779b1
    s_add_u32 s69, s69, 0x7f4a7c15
    s_lshr_b32 s60, s56, 1
    s_lshl_b32 s60, s60, 4
    s_lshr_b32 s60, s72, s60
    s_lshl_b32 s60, s60, 16
    v_mov_b32 v44, 0x3fb8aa3b
    v_mul_f32 v44, s60, v44
    v_exp_f32 v44, v44
    s_nop 0
    v_cvt_pk_bf16_f32 v44, 0, v44
    s_waitcnt vmcnt(4)
    v_lshlrev_b32 v24, 16, v24
    v_lshlrev_b32 v25, 16, v25
    v_lshlrev_b32 v26, 16, v26
    v_lshlrev_b32 v27, 16, v27
    v_lshlrev_b32 v28, 16, v28
    v_lshlrev_b32 v29, 16, v29
    v_pk_mul_f32 v[40:41], v[24:25], v[44:45] op_sel_hi:[1,0]
    v_pk_mul_f32 v[26:27], v[26:27], v[44:45] op_sel_hi:[1,0]
    v_mul_f32 v44, 0x4138aa3b, v40
    v_mul_f32 v45, 0x3fa2f983, v41
    v_mul_f32 v46, 0x3fb8aa3b, v40
    v_mul_f32 v47, 0x3e22f983, v41
    v_mul_f32 v48, 0x43b8aa3b, v40
    v_mul_f32 v49, 0x4222f983, v41
    v_fract_f32 v45, v45
    v_exp_f32 v44, v44
    v_fract_f32 v47, v47
    v_exp_f32 v46, v46
    v_fract_f32 v49, v49
    v_exp_f32 v48, v48
    v_cos_f32 v30, v45
    v_sin_f32 v31, v45
    v_cos_f32 v32, v47
    v_sin_f32 v33, v47
    v_cos_f32 v34, v49
    v_sin_f32 v35, v49
    v_pk_mul_f32 v[42:43], v[28:29], v[26:27] op_sel_hi:[1,0]
    v_pk_fma_f32 v[42:43], v[28:29], v[26:27], v[42:43] op_sel:[1,1,0] op_sel_hi:[0,1,1] neg_lo:[0,1,0]
    v_pk_mul_f32 v[30:31], v[30:31], v[44:45] op_sel_hi:[1,0]
    v_pk_mul_f32 v[32:33], v[32:33], v[46:47] op_sel_hi:[1,0]
    v_pk_mul_f32 v[34:35], v[34:35], v[48:49] op_sel_hi:[1,0]
    v_pk_mul_f32 v[36:37], v[30:31], v[30:31] op_sel_hi:[1,0]
    v_pk_mul_f32 v[38:39], v[32:33], v[32:33] op_sel_hi:[1,0]
    v_pk_fma_f32 v[36:37], v[30:31], v[30:31], v[36:37] op_sel:[1,1,0] op_sel_hi:[0,1,1] neg_lo:[0,1,0]
    v_pk_fma_f32 v[38:39], v[32:33], v[32:33], v[38:39] op_sel:[1,1,0] op_sel_hi:[0,1,1] neg_lo:[0,1,0]
    v_pk_mul_f32 v[118:119], v[30:31], v[36:37] op_sel_hi:[1,0]
    v_pk_mul_f32 v[176:177], v[42:43], v[32:33] op_sel_hi:[1,0]
    v_pk_mul_f32 v[178:179], v[42:43], v[38:39] op_sel_hi:[1,0]
    v_pk_fma_f32 v[118:119], v[30:31], v[36:37], v[118:119] op_sel:[1,1,0] op_sel_hi:[0,1,1] neg_lo:[0,1,0]
    v_pk_mul_f32 v[190:191], v[42:43], v[34:35] op_sel_hi:[1,0]
    v_pk_mul_f32 v[120:121], v[36:37], v[36:37] op_sel_hi:[1,0]
    v_pk_fma_f32 v[176:177], v[42:43], v[32:33], v[176:177] op_sel:[1,1,0] op_sel_hi:[0,1,1] neg_lo:[0,1,0]
    v_pk_mul_f32 v[122:123], v[118:119], v[36:37] op_sel_hi:[1,0]
    v_pk_fma_f32 v[178:179], v[42:43], v[38:39], v[178:179] op_sel:[1,1,0] op_sel_hi:[0,1,1] neg_lo:[0,1,0]
    v_pk_fma_f32 v[120:121], v[36:37], v[36:37], v[120:121] op_sel:[1,1,0] op_sel_hi:[0,1,1] neg_lo:[0,1,0]
    v_pk_fma_f32 v[190:191], v[42:43], v[34:35], v[190:191] op_sel:[1,1,0] op_sel_hi:[0,1,1] neg_lo:[0,1,0]
    v_pk_mul_f32 v[180:181], v[176:177], v[38:39] op_sel_hi:[1,0]
    v_pk_fma_f32 v[122:123], v[118:119], v[36:37], v[122:123] op_sel:[1,1,0] op_sel_hi:[0,1,1] neg_lo:[0,1,0]
    v_pk_mul_f32 v[182:183], v[178:179], v[38:39] op_sel_hi:[1,0]
    v_pk_mul_f32 v[124:125], v[120:121], v[36:37] op_sel_hi:[1,0]
    v_pk_mul_f32 v[198:199], v[190:191], v[34:35] op_sel_hi:[1,0]
    v_pk_mul_f32 v[126:127], v[122:123], v[36:37] op_sel_hi:[1,0]
    v_pk_mul_f32 v[192:193], v[178:179], v[34:35] op_sel_hi:[1,0]
    v_pk_fma_f32 v[124:125], v[120:121], v[36:37], v[124:125] op_sel:[1,1,0] op_sel_hi:[0,1,1] neg_lo:[0,1,0]
    v_pk_fma_f32 v[180:181], v[176:177], v[38:39], v[180:181] op_sel:[1,1,0] op_sel_hi:[0,1,1] neg_lo:[0,1,0]
    v_pk_fma_f32 v[182:183], v[178:179], v[38:39], v[182:183] op_sel:[1,1,0] op_sel_hi:[0,1,1] neg_lo:[0,1,0]
    v_pk_fma_f32 v[126:127], v[122:123], v[36:37], v[126:127] op_sel:[1,1,0] op_sel_hi:[0,1,1] neg_lo:[0,1,0]
    v_pk_fma_f32 v[198:199], v[190:191], v[34:35], v[198:199] op_sel:[1,1,0] op_sel_hi:[0,1,1] neg_lo:[0,1,0]
    v_pk_mul_f32 v[128:129], v[124:125], v[36:37] op_sel_hi:[1,0]
    v_pk_fma_f32 v[192:193], v[178:179], v[34:35], v[192:193] op_sel:[1,1,0] op_sel_hi:[0,1,1] neg_lo:[0,1,0]
    v_pk_mul_f32 v[130:131], v[126:127], v[36:37] op_sel_hi:[1,0]
    v_pk_mul_f32 v[184:185], v[180:181], v[38:39] op_sel_hi:[1,0]
    v_pk_fma_f32 v[128:129], v[124:125], v[36:37], v[128:129] op_sel:[1,1,0] op_sel_hi:[0,1,1] neg_lo:[0,1,0]
    v_pk_mul_f32 v[186:187], v[182:183], v[38:39] op_sel_hi:[1,0]
    v_pk_mul_f32 v[202:203], v[198:199], v[34:35] op_sel_hi:[1,0]
    v_pk_fma_f32 v[130:131], v[126:127], v[36:37], v[130:131] op_sel:[1,1,0] op_sel_hi:[0,1,1] neg_lo:[0,1,0]
    v_pk_mul_f32 v[194:195], v[182:183], v[34:35] op_sel_hi:[1,0]
    v_pk_mul_f32 v[132:133], v[128:129], v[36:37] op_sel_hi:[1,0]
    v_pk_fma_f32 v[184:185], v[180:181], v[38:39], v[184:185] op_sel:[1,1,0] op_sel_hi:[0,1,1] neg_lo:[0,1,0]
    v_pk_mul_f32 v[134:135], v[130:131], v[36:37] op_sel_hi:[1,0]
    v_pk_fma_f32 v[186:187], v[182:183], v[38:39], v[186:187] op_sel:[1,1,0] op_sel_hi:[0,1,1] neg_lo:[0,1,0]
    v_pk_fma_f32 v[132:133], v[128:129], v[36:37], v[132:133] op_sel:[1,1,0] op_sel_hi:[0,1,1] neg_lo:[0,1,0]
    v_pk_fma_f32 v[202:203], v[198:199], v[34:35], v[202:203] op_sel:[1,1,0] op_sel_hi:[0,1,1] neg_lo:[0,1,0]
    v_pk_fma_f32 v[194:195], v[182:183], v[34:35], v[194:195] op_sel:[1,1,0] op_sel_hi:[0,1,1] neg_lo:[0,1,0]
    v_pk_fma_f32 v[134:135], v[130:131], v[36:37], v[134:135] op_sel:[1,1,0] op_sel_hi:[0,1,1] neg_lo:[0,1,0]
    v_pk_mul_f32 v[188:189], v[184:185], v[38:39] op_sel_hi:[1,0]
    v_pk_mul_f32 v[136:137], v[132:133], v[36:37] op_sel_hi:[1,0]
    v_pk_mul_f32 v[196:197], v[186:187], v[34:35] op_sel_hi:[1,0]
    v_pk_mul_f32 v[138:139], v[134:135], v[36:37] op_sel_hi:[1,0]
    v_pk_mul_f32 v[206:207], v[202:203], v[34:35] op_sel_hi:[1,0]
    v_pk_fma_f32 v[136:137], v[132:133], v[36:37], v[136:137] op_sel:[1,1,0] op_sel_hi:[0,1,1] neg_lo:[0,1,0]
    v_pk_mul_f32 v[200:201], v[194:195], v[34:35] op_sel_hi:[1,0]
    v_pk_fma_f32 v[188:189], v[184:185], v[38:39], v[188:189] op_sel:[1,1,0] op_sel_hi:[0,1,1] neg_lo:[0,1,0]
    v_pk_fma_f32 v[138:139], v[134:135], v[36:37], v[138:139] op_sel:[1,1,0] op_sel_hi:[0,1,1] neg_lo:[0,1,0]
    v_pk_fma_f32 v[196:197], v[186:187], v[34:35], v[196:197] op_sel:[1,1,0] op_sel_hi:[0,1,1] neg_lo:[0,1,0]
    v_pk_mul_f32 v[140:141], v[136:137], v[36:37] op_sel_hi:[1,0]
    v_pk_fma_f32 v[206:207], v[202:203], v[34:35], v[206:207] op_sel:[1,1,0] op_sel_hi:[0,1,1] neg_lo:[0,1,0]
    v_pk_mul_f32 v[142:143], v[138:139], v[36:37] op_sel_hi:[1,0]
    v_pk_fma_f32 v[200:201], v[194:195], v[34:35], v[200:201] op_sel:[1,1,0] op_sel_hi:[0,1,1] neg_lo:[0,1,0]
    v_pk_fma_f32 v[140:141], v[136:137], v[36:37], v[140:141] op_sel:[1,1,0] op_sel_hi:[0,1,1] neg_lo:[0,1,0]
    v_pk_mul_f32 v[204:205], v[200:201], v[34:35] op_sel_hi:[1,0]
    v_pk_mul_f32 v[208:209], v[206:207], v[34:35] op_sel_hi:[1,0]
    v_pk_fma_f32 v[142:143], v[138:139], v[36:37], v[142:143] op_sel:[1,1,0] op_sel_hi:[0,1,1] neg_lo:[0,1,0]
    v_pk_fma_f32 v[204:205], v[200:201], v[34:35], v[204:205] op_sel:[1,1,0] op_sel_hi:[0,1,1] neg_lo:[0,1,0]
    v_pk_mul_f32 v[144:145], v[140:141], v[36:37] op_sel_hi:[1,0]
    v_pk_fma_f32 v[208:209], v[206:207], v[34:35], v[208:209] op_sel:[1,1,0] op_sel_hi:[0,1,1] neg_lo:[0,1,0]
    v_pk_mul_f32 v[146:147], v[142:143], v[36:37] op_sel_hi:[1,0]
    v_pk_mul_f32 v[210:211], v[208:209], v[34:35] op_sel_hi:[1,0]
    v_pk_fma_f32 v[144:145], v[140:141], v[36:37], v[144:145] op_sel:[1,1,0] op_sel_hi:[0,1,1] neg_lo:[0,1,0]
    v_pk_fma_f32 v[210:211], v[208:209], v[34:35], v[210:211] op_sel:[1,1,0] op_sel_hi:[0,1,1] neg_lo:[0,1,0]
    v_pk_fma_f32 v[146:147], v[142:143], v[36:37], v[146:147] op_sel:[1,1,0] op_sel_hi:[0,1,1] neg_lo:[0,1,0]
    v_cvt_pk_bf16_f32 v88, v42, v176
    v_cvt_pk_bf16_f32 v100, -v43, -v177
    v_pk_mul_f32 v[148:149], v[144:145], v[36:37] op_sel_hi:[1,0]
    v_cvt_pk_bf16_f32 v89, v178, v180
    v_pk_mul_f32 v[150:151], v[146:147], v[36:37] op_sel_hi:[1,0]
    v_cvt_pk_bf16_f32 v101, -v179, -v181
    v_pk_fma_f32 v[148:149], v[144:145], v[36:37], v[148:149] op_sel:[1,1,0] op_sel_hi:[0,1,1] neg_lo:[0,1,0]
    v_cvt_pk_bf16_f32 v90, v182, v184
    v_pk_fma_f32 v[150:151], v[146:147], v[36:37], v[150:151] op_sel:[1,1,0] op_sel_hi:[0,1,1] neg_lo:[0,1,0]
    v_cvt_pk_bf16_f32 v102, -v183, -v185
    v_pk_mul_f32 v[212:213], v[210:211], v[34:35] op_sel_hi:[1,0]
    v_pk_mul_f32 v[152:153], v[148:149], v[36:37] op_sel_hi:[1,0]
    v_pk_fma_f32 v[212:213], v[210:211], v[34:35], v[212:213] op_sel:[1,1,0] op_sel_hi:[0,1,1] neg_lo:[0,1,0]
    v_pk_mul_f32 v[154:155], v[150:151], v[36:37] op_sel_hi:[1,0]
    v_cvt_pk_bf16_f32 v91, v186, v188
    v_pk_fma_f32 v[152:153], v[148:149], v[36:37], v[152:153] op_sel:[1,1,0] op_sel_hi:[0,1,1] neg_lo:[0,1,0]
    v_cvt_pk_bf16_f32 v103, -v187, -v189
    v_pk_fma_f32 v[154:155], v[150:151], v[36:37], v[154:155] op_sel:[1,1,0] op_sel_hi:[0,1,1] neg_lo:[0,1,0]
    v_cvt_pk_bf16_f32 v92, v190, v192
    v_cvt_pk_bf16_f32 v104, -v191, -v193
    v_pk_mul_f32 v[156:157], v[152:153], v[36:37] op_sel_hi:[1,0]
    v_cvt_pk_bf16_f32 v93, v194, v196
    v_pk_mul_f32 v[158:159], v[154:155], v[36:37] op_sel_hi:[1,0]
    v_cvt_pk_bf16_f32 v105, -v195, -v197
    v_pk_fma_f32 v[156:157], v[152:153], v[36:37], v[156:157] op_sel:[1,1,0] op_sel_hi:[0,1,1] neg_lo:[0,1,0]
    v_pk_mul_f32 v[214:215], v[212:213], v[34:35] op_sel_hi:[1,0]
    v_pk_fma_f32 v[158:159], v[154:155], v[36:37], v[158:159] op_sel:[1,1,0] op_sel_hi:[0,1,1] neg_lo:[0,1,0]
    v_pk_fma_f32 v[214:215], v[212:213], v[34:35], v[214:215] op_sel:[1,1,0] op_sel_hi:[0,1,1] neg_lo:[0,1,0]
    v_cvt_pk_bf16_f32 v94, v198, v200
    v_pk_mul_f32 v[160:161], v[156:157], v[36:37] op_sel_hi:[1,0]
    v_cvt_pk_bf16_f32 v106, -v199, -v201
    v_pk_mul_f32 v[162:163], v[158:159], v[36:37] op_sel_hi:[1,0]
    v_cvt_pk_bf16_f32 v95, v202, v204
    v_pk_fma_f32 v[160:161], v[156:157], v[36:37], v[160:161] op_sel:[1,1,0] op_sel_hi:[0,1,1] neg_lo:[0,1,0]
    v_cvt_pk_bf16_f32 v107, -v203, -v205
    v_pk_fma_f32 v[162:163], v[158:159], v[36:37], v[162:163] op_sel:[1,1,0] op_sel_hi:[0,1,1] neg_lo:[0,1,0]
    v_cvt_pk_bf16_f32 v96, v206, v208
    v_cvt_pk_bf16_f32 v108, -v207, -v209
    v_pk_mul_f32 v[164:165], v[160:161], v[36:37] op_sel_hi:[1,0]
    v_mov_b32 v99, 0
    v_pk_mul_f32 v[166:167], v[162:163], v[36:37] op_sel_hi:[1,0]
    v_mov_b32 v111, 0
    v_pk_fma_f32 v[164:165], v[160:161], v[36:37], v[164:165] op_sel:[1,1,0] op_sel_hi:[0,1,1] neg_lo:[0,1,0]
    v_permlane32_swap_b32 v88, v92
    v_pk_fma_f32 v[166:167], v[162:163], v[36:37], v[166:167] op_sel:[1,1,0] op_sel_hi:[0,1,1] neg_lo:[0,1,0]
    v_permlane32_swap_b32 v89, v93
    v_permlane32_swap_b32 v90, v94
    v_pk_mul_f32 v[168:169], v[164:165], v[36:37] op_sel_hi:[1,0]
    v_permlane32_swap_b32 v91, v95
    v_pk_mul_f32 v[170:171], v[166:167], v[36:37] op_sel_hi:[1,0]
    v_cvt_pk_bf16_f32 v97, v210, v212
    v_pk_fma_f32 v[168:169], v[164:165], v[36:37], v[168:169] op_sel:[1,1,0] op_sel_hi:[0,1,1] neg_lo:[0,1,0]
    v_cvt_pk_bf16_f32 v109, -v211, -v213
    v_pk_fma_f32 v[170:171], v[166:167], v[36:37], v[170:171] op_sel:[1,1,0] op_sel_hi:[0,1,1] neg_lo:[0,1,0]
    v_cvt_pk_bf16_f32 v98, v214, v214
    v_cvt_pk_bf16_f32 v110, -v215, -v215
    v_pk_mul_f32 v[172:173], v[168:169], v[36:37] op_sel_hi:[1,0]
    v_permlane32_swap_b32 v100, v104
    v_pk_mul_f32 v[174:175], v[170:171], v[36:37] op_sel_hi:[1,0]
    v_permlane32_swap_b32 v101, v105
    v_pk_fma_f32 v[172:173], v[168:169], v[36:37], v[172:173] op_sel:[1,1,0] op_sel_hi:[0,1,1] neg_lo:[0,1,0]
    v_permlane32_swap_b32 v102, v106
    v_pk_fma_f32 v[174:175], v[170:171], v[36:37], v[174:175] op_sel:[1,1,0] op_sel_hi:[0,1,1] neg_lo:[0,1,0]
    v_permlane32_swap_b32 v103, v107
    v_mfma_f32_32x32x16_bf16 v[176:191], v[88:91], v[240:243], 0
    v_cvt_pk_bf16_f32 v56, 1.0, v30
    v_cvt_pk_bf16_f32 v57, v36, v118
    v_cvt_pk_bf16_f32 v58, v120, v122
    v_cvt_pk_bf16_f32 v59, v124, v126
    v_cvt_pk_bf16_f32 v60, v128, v130
    v_cvt_pk_bf16_f32 v61, v132, v134
    v_mfma_f32_32x32x16_bf16 v[192:207], v[92:95], v[240:243], 0
    v_cvt_pk_bf16_f32 v62, v136, v138
    v_cvt_pk_bf16_f32 v63, v140, v142
    v_cvt_pk_bf16_f32 v72, 0, v31
    v_cvt_pk_bf16_f32 v73, v37, v119
    v_cvt_pk_bf16_f32 v74, v121, v123
    v_cvt_pk_bf16_f32 v75, v125, v127
    v_mfma_f32_32x32x16_bf16 v[208:223], v[100:103], v[240:243], 0
    v_cvt_pk_bf16_f32 v76, v129, v131
    v_cvt_pk_bf16_f32 v77, v133, v135
    v_cvt_pk_bf16_f32 v78, v137, v139
    v_cvt_pk_bf16_f32 v79, v141, v143
    v_permlane32_swap_b32 v56, v60
    v_permlane32_swap_b32 v57, v61
    v_mfma_f32_32x32x16_bf16 v[224:239], v[104:107], v[240:243], 0
    v_permlane32_swap_b32 v58, v62
    v_permlane32_swap_b32 v59, v63
    v_permlane32_swap_b32 v72, v76
    v_permlane32_swap_b32 v73, v77
    v_permlane32_swap_b32 v74, v78
    v_permlane32_swap_b32 v75, v79
    v_mfma_f32_32x32x16_bf16 v[176:191], v[96:99], v[248:251], v[176:191]
    v_cvt_pk_bf16_f32 v64, v144, v146
    v_cvt_pk_bf16_f32 v65, v148, v150
    v_cvt_pk_bf16_f32 v66, v152, v154
    v_cvt_pk_bf16_f32 v67, v156, v158
    v_cvt_pk_bf16_f32 v68, v160, v162
    v_cvt_pk_bf16_f32 v69, v164, v166
    v_mfma_f32_32x32x16_bf16 v[192:207], v[96:99], v[252:255], v[192:207]
    v_cvt_pk_bf16_f32 v70, v168, v170
    v_cvt_pk_bf16_f32 v71, v172, v174
    v_cvt_pk_bf16_f32 v80, v145, v147
    v_cvt_pk_bf16_f32 v81, v149, v151
    v_cvt_pk_bf16_f32 v82, v153, v155
    v_cvt_pk_bf16_f32 v83, v157, v159
    v_mfma_f32_32x32x16_bf16 v[208:223], v[108:111], v[248:251], v[208:223]
    v_cvt_pk_bf16_f32 v84, v161, v163
    v_cvt_pk_bf16_f32 v85, v165, v167
    v_cvt_pk_bf16_f32 v86, v169, v171
    v_cvt_pk_bf16_f32 v87, v173, v175
    v_permlane32_swap_b32 v64, v68
    v_permlane32_swap_b32 v65, v69
    v_mfma_f32_32x32x16_bf16 v[224:239], v[108:111], v[252:255], v[224:239]
    v_permlane32_swap_b32 v66, v70
    v_permlane32_swap_b32 v67, v71
    v_permlane32_swap_b32 v80, v84
    v_permlane32_swap_b32 v81, v85
    v_permlane32_swap_b32 v82, v86
    v_permlane32_swap_b32 v83, v87
    v_mfma_f32_32x32x16_bf16 v[112:127], v[56:59], v[240:243], 0
    v_cvt_pk_bf16_f32 v176, v176, v177
    v_cvt_pk_bf16_f32 v177, v178, v179
    v_cvt_pk_bf16_f32 v178, v180, v181
    v_cvt_pk_bf16_f32 v179, v182, v183
    v_cvt_pk_bf16_f32 v180, v184, v185
    v_mfma_f32_32x32x16_bf16 v[112:127], v[64:67], v[244:247], v[112:127]
    v_cvt_pk_bf16_f32 v181, v186, v187
    v_cvt_pk_bf16_f32 v182, v188, v189
    v_cvt_pk_bf16_f32 v183, v190, v191
    v_cvt_pk_bf16_f32 v192, v192, v193
    v_cvt_pk_bf16_f32 v193, v194, v195
    v_mfma_f32_32x32x16_bf16 v[128:143], v[60:63], v[240:243], 0
    v_cvt_pk_bf16_f32 v194, v196, v197
    v_cvt_pk_bf16_f32 v195, v198, v199
    v_cvt_pk_bf16_f32 v196, v200, v201
    v_cvt_pk_bf16_f32 v197, v202, v203
    v_cvt_pk_bf16_f32 v198, v204, v205
    v_mfma_f32_32x32x16_bf16 v[128:143], v[68:71], v[244:247], v[128:143]
    v_cvt_pk_bf16_f32 v199, v206, v207
    v_cvt_pk_bf16_f32 v208, v208, v209
    v_cvt_pk_bf16_f32 v209, v210, v211
    v_cvt_pk_bf16_f32 v210, v212, v213
    v_cvt_pk_bf16_f32 v211, v214, v215
    v_mfma_f32_32x32x16_bf16 v[144:159], v[72:75], v[240:243], 0
    v_cvt_pk_bf16_f32 v212, v216, v217
    v_cvt_pk_bf16_f32 v213, v218, v219
    v_cvt_pk_bf16_f32 v214, v220, v221
    v_cvt_pk_bf16_f32 v215, v222, v223
    v_cvt_pk_bf16_f32 v224, v224, v225
    v_cvt_pk_bf16_f32 v225, v226, v227
    v_mfma_f32_32x32x16_bf16 v[144:159], v[80:83], v[244:247], v[144:159]
    v_cvt_pk_bf16_f32 v226, v228, v229
    v_cvt_pk_bf16_f32 v227, v230, v231
    v_cvt_pk_bf16_f32 v228, v232, v233
    v_cvt_pk_bf16_f32 v229, v234, v235
    v_cvt_pk_bf16_f32 v230, v236, v237
    v_cvt_pk_bf16_f32 v231, v238, v239
    v_mfma_f32_32x32x16_bf16 v[160:175], v[76:79], v[240:243], 0
    v_cvt_pk_bf16_f32 v112, v112, v113
    v_cvt_pk_bf16_f32 v113, v114, v115
    v_cvt_pk_bf16_f32 v114, v116, v117
    v_cvt_pk_bf16_f32 v115, v118, v119
    v_cvt_pk_bf16_f32 v116, v120, v121
    v_cvt_pk_bf16_f32 v117, v122, v123
    v_mfma_f32_32x32x16_bf16 v[160:175], v[84:87], v[244:247], v[160:175]
    v_cvt_pk_bf16_f32 v118, v124, v125
    v_cvt_pk_bf16_f32 v119, v126, v127
    v_cvt_pk_bf16_f32 v128, v128, v129
    v_cvt_pk_bf16_f32 v129, v130, v131
    v_cvt_pk_bf16_f32 v130, v132, v133
    v_cvt_pk_bf16_f32 v131, v134, v135
    v_mfma_f32_32x32x16_bf16 v[56:71], v[176:179], v[112:115], 0
    v_cvt_pk_bf16_f32 v132, v136, v137
    v_cvt_pk_bf16_f32 v133, v138, v139
    v_cvt_pk_bf16_f32 v134, v140, v141
    v_cvt_pk_bf16_f32 v135, v142, v143
    v_mfma_f32_32x32x16_bf16 v[56:71], v[180:183], v[116:119], v[56:71]
    v_cvt_pk_bf16_f32 v144, v144, v145
    v_cvt_pk_bf16_f32 v145, v146, v147
    v_cvt_pk_bf16_f32 v146, v148, v149
    v_cvt_pk_bf16_f32 v147, v150, v151
    v_mfma_f32_32x32x16_bf16 v[56:71], v[192:195], v[128:131], v[56:71]
    v_cvt_pk_bf16_f32 v148, v152, v153
    v_cvt_pk_bf16_f32 v149, v154, v155
    v_cvt_pk_bf16_f32 v150, v156, v157
    v_cvt_pk_bf16_f32 v151, v158, v159
    v_mfma_f32_32x32x16_bf16 v[56:71], v[196:199], v[132:135], v[56:71]
    v_cvt_pk_bf16_f32 v160, v160, v161
    v_cvt_pk_bf16_f32 v161, v162, v163
    v_cvt_pk_bf16_f32 v162, v164, v165
    v_cvt_pk_bf16_f32 v163, v166, v167
    v_mfma_f32_32x32x16_bf16 v[56:71], v[208:211], v[144:147], v[56:71]
    v_cvt_pk_bf16_f32 v164, v168, v169
    v_cvt_pk_bf16_f32 v165, v170, v171
    v_cvt_pk_bf16_f32 v166, v172, v173
    v_cvt_pk_bf16_f32 v167, v174, v175
    v_mfma_f32_32x32x16_bf16 v[56:71], v[212:215], v[148:151], v[56:71]
    v_mfma_f32_32x32x16_bf16 v[56:71], v[224:227], v[160:163], v[56:71]
    v_mfma_f32_32x32x16_bf16 v[56:71], v[228:231], v[164:167], v[56:71]
    s_setprio 2
    s_waitcnt lgkmcnt(0)
    s_waitcnt vmcnt(0)
    s_barrier
    s_bfe_u32 s67, s68, 0x40008
    s_lshl_b32 s66, s67, 7
    s_mul_i32 s67, s67, 229376
    s_lshr_b32 s60, s56, 1
    s_lshl_b32 s60, s60, 13
    s_add_u32 s60, s60, 65536
    s_and_b32 s61, s56, 1
    s_mul_i32 s61, s61, 5120
    s_add_u32 s62, s60, s61
    v_lshl_add_u32 v20, v1, 4, s62
    s_sub_u32 s62, s60, s61
    s_add_u32 s62, s62, 5120
    s_mov_b32 m0, s86
    s_nop 0
    buffer_load_dwordx4 v8, s[40:43], s66 offen offset:0  lds
    v_lshl_add_u32 v21, v1, 4, s62
    s_add_u32 s77, s60, 3072
    ds_write_b128 v20, v[56:59] offset:0
    ds_write_b128 v20, v[60:63] offset:1024
    ds_write_b128 v20, v[64:67] offset:2048
    v_lshlrev_b32 v144, 3, v0
    v_cvt_f32_u32 v144, v144
    v_lshlrev_b32 v156, 4, v0
    v_add_f32 v145, 0x3f800000, v144
    buffer_load_dwordx4 v9, s[40:43], s66 offen offset:1024  lds
    v_add_f32 v146, 0x40000000, v144
    v_add_f32 v147, 0x40400000, v144
    v_add_f32 v148, 0x40800000, v144
    v_add_f32 v149, 0x40a00000, v144
    v_add_f32 v150, 0x40c00000, v144
    v_add_f32 v151, 0x40e00000, v144
    v_add_f32 v152, 0x41000000, v144
    v_add_f32 v153, 0x41100000, v144
    v_add_f32 v154, 0x41200000, v144
    buffer_load_dwordx4 v10, s[40:43], s66 offen offset:2048  lds
    v_add_f32 v155, 0x41300000, v144
    v_cvt_pk_bf16_f32 v144, v144, v145
    v_cvt_pk_bf16_f32 v146, v146, v147
    v_cvt_pk_bf16_f32 v148, v148, v149
    v_cvt_pk_bf16_f32 v150, v150, v151
    v_cvt_pk_bf16_f32 v152, v152, v153
    v_cvt_pk_bf16_f32 v154, v154, v155
    v_cmp_gt_u32 s[26:27], 16, v0
    v_lshlrev_b32_sdwa v24, 1, v144 dst_sel:DWORD dst_unused:UNUSED_PAD src0_sel:DWORD src1_sel:WORD_0
    buffer_load_dwordx4 v11, s[40:43], s66 offen offset:3072  lds
    v_add_u32 v145, 34048, v156
    v_cndmask_b32 v24, v24, v145, s[26:27]
    v_lshlrev_b32_sdwa v25, 1, v144 dst_sel:DWORD dst_unused:UNUSED_PAD src0_sel:DWORD src1_sel:WORD_1
    v_add_u32 v145, 34050, v156
    v_cndmask_b32 v25, v25, v145, s[26:27]
    v_lshlrev_b32_sdwa v26, 1, v146 dst_sel:DWORD dst_unused:UNUSED_PAD src0_sel:DWORD src1_sel:WORD_0
    v_add_u32 v145, 34052, v156
    v_cndmask_b32 v26, v26, v145, s[26:27]
    v_lshlrev_b32_sdwa v27, 1, v146 dst_sel:DWORD dst_unused:UNUSED_PAD src0_sel:DWORD src1_sel:WORD_1
    s_mov_b32 m0, s87
    s_nop 0
    buffer_load_dwordx4 v12, s[40:43], s66 offen offset:0  lds
    v_add_u32 v145, 34054, v156
    v_cndmask_b32 v27, v27, v145, s[26:27]
    v_lshlrev_b32_sdwa v28, 1, v148 dst_sel:DWORD dst_unused:UNUSED_PAD src0_sel:DWORD src1_sel:WORD_0
    v_add_u32 v145, 34056, v156
    v_cndmask_b32 v28, v28, v145, s[26:27]
    v_lshlrev_b32_sdwa v29, 1, v148 dst_sel:DWORD dst_unused:UNUSED_PAD src0_sel:DWORD src1_sel:WORD_1
    v_add_u32 v145, 34058, v156
    v_cndmask_b32 v29, v29, v145, s[26:27]
    v_lshlrev_b32_sdwa v30, 1, v150 dst_sel:DWORD dst_unused:UNUSED_PAD src0_sel:DWORD src1_sel:WORD_0
    buffer_load_dwordx4 v13, s[40:43], s66 offen offset:1024  lds
    v_add_u32 v145, 34060, v156
    v_cndmask_b32 v30, v30, v145, s[26:27]
    v_lshlrev_b32_sdwa v31, 1, v150 dst_sel:DWORD dst_unused:UNUSED_PAD src0_sel:DWORD src1_sel:WORD_1
    v_add_u32 v145, 34062, v156
    v_cndmask_b32 v31, v31, v145, s[26:27]
    v_lshlrev_b32_sdwa v32, 1, v152 dst_sel:DWORD dst_unused:UNUSED_PAD src0_sel:DWORD src1_sel:WORD_0
    v_add_u32 v145, 34064, v156
    v_cndmask_b32 v32, v32, v145, s[26:27]
    v_lshlrev_b32_sdwa v33, 1, v152 dst_sel:DWORD dst_unused:UNUSED_PAD src0_sel:DWORD src1_sel:WORD_1
    buffer_load_dwordx4 v14, s[40:43], s66 offen offset:2048  lds
    v_add_u32 v145, 34066, v156
    v_cndmask_b32 v33, v33, v145, s[26:27]
    v_lshlrev_b32_sdwa v34, 1, v154 dst_sel:DWORD dst_unused:UNUSED_PAD src0_sel:DWORD src1_sel:WORD_0
    v_add_u32 v145, 34068, v156
    v_cndmask_b32 v34, v34, v145, s[26:27]
    v_add_u32 v35, 114720, v156
    s_and_b32 s60, s57, 1
    s_lshl_b32 s60, s60, 4
    s_and_b32 s61, s57, 2
    buffer_load_dwordx4 v15, s[40:43], s66 offen offset:3072  lds
    s_lshl_b32 s61, s61, 2
    s_add_u32 s60, s60, s61
    s_lshr_b32 s78, s58, 2
    s_add_u32 s73, s60, s78
    s_and_b32 s60, s57, 4
    s_and_b32 s61, s58, 3
    s_add_u32 s74, s60, s61
    s_mov_b32 s89, 0
    s_mov_b32 s90, 2048
    s_mov_b32 m0, s88
    s_nop 0
    buffer_load_dwordx4 v16, s[44:47], s67 offen offset:0  lds
    s_mov_b32 s91, 4096
    s_mov_b32 s92, 6144
    s_mov_b32 s93, 8192
    s_mov_b32 s94, 10240
    s_mov_b32 s95, 12288
    s_lshl_b32 s60, s74, 1
    s_and_b32 s61, s56, 1
    s_add_u32 s60, s60, s61
    s_mul_i32 s60, s60, 114688
    buffer_load_dwordx4 v17, s[44:47], s67 offen offset:1024  lds
    s_mul_i32 s61, s78, 7168
    s_add_u32 s60, s60, s61
    s_lshr_b32 s61, s56, 1
    s_mul_i32 s61, s61, 3584
    s_add_u32 s60, s60, s61
    s_add_u32 s79, s60, 0x500000
    v_min_u32 v52, 27, v1
    v_lshlrev_b32 v52, 7, v52
    v_and_b32 v23, 15, v1
    buffer_load_dwordx4 v18, s[44:47], s67 offen offset:2048  lds
    v_min_u32 v23, 13, v23
    v_bfe_u32 v2, v1, 4, 1
    v_mul_u32_u24 v2, 56, v2
    v_sub_u32 v23, v23, v2
    s_mul_i32 s60, s59, 14
    v_add_u32 v23, s60, v23
    v_lshlrev_b32 v23, 10, v23
    s_lshl_b32 s60, s74, 7
    s_add_u32 s60, s60, 0x40000
    buffer_load_dwordx4 v19, s[44:47], s67 offen offset:3072  lds
    v_add_u32 v23, s60, v23
    s_mul_i32 s60, s59, 14
    s_mul_i32 s61, s74, 224
    s_add_u32 s61, s61, s60
    s_lshl_b32 s61, s61, 10
    s_add_u32 s61, s61, 0x500000
    v_lshl_add_u32 v54, v1, 4, s61
    v_add_u32 v55, 114688, v54
    s_mul_i32 s101, s3, 2
    buffer_load_dword v6, v53, s[4:7], s101 offen
    s_waitcnt lgkmcnt(0)
    s_barrier
    ds_read_b128 v[112:115], v21 offset:0
    s_bfe_u32 s67, s68, 0x4000c
    s_lshl_b32 s66, s67, 7
    s_mul_i32 s67, s67, 229376
    ds_read_b128 v[116:119], v21 offset:1024
    ds_read_b128 v[120:123], v21 offset:2048
    v_and_b32 v44, 31, v1
    v_lshrrev_b32 v45, 5, v1
    v_lshlrev_b32 v46, 3, v45
    v_lshl_add_u32 v46, v44, 4, v46
    v_add_u32 v46, s77, v46
    v_cmp_gt_u32 vcc, 32, v1
    v_lshlrev_b32 v47, 3, v44
    v_add_u32 v47, 512, v47
    s_mov_b32 m0, s80
    s_nop 0
    buffer_load_dwordx4 v8, s[40:43], s66 offen offset:0  lds
    v_lshlrev_b32 v48, 2, v44
    v_add_u32 v48, 768, v48
    v_cndmask_b32 v47, v48, v47, vcc
    v_add_u32 v47, s77, v47
    v_mov_b32 v48, 128
    v_cndmask_b32 v48, v48, 4, vcc
    v_add_u32 v48, v48, v47
    v_lshlrev_b32 v49, 8, v45
    v_lshl_add_u32 v49, v44, 1, v49
    v_add_u32 v49, s77, v49
    buffer_load_dwordx4 v9, s[40:43], s66 offen offset:1024  lds
    s_waitcnt lgkmcnt(0)
    v_add_f32 v56, v56, v112
    v_add_f32 v57, v57, v113
    v_add_f32 v58, v58, v114
    v_add_f32 v59, v59, v115
    v_add_f32 v60, v60, v116
    v_add_f32 v61, v61, v117
    v_add_f32 v62, v62, v118
    v_add_f32 v63, v63, v119
    v_add_f32 v64, v64, v120
    buffer_load_dwordx4 v10, s[40:43], s66 offen offset:2048  lds
    v_add_f32 v65, v65, v121
    v_add_f32 v66, v66, v122
    v_add_f32 v67, v67, v123
    v_cvt_pk_bf16_f32 v112, v56, v57
    v_cvt_pk_bf16_f32 v113, v58, v59
    v_cvt_pk_bf16_f32 v114, v60, v61
    v_cvt_pk_bf16_f32 v115, v62, v63
    v_cvt_pk_bf16_f32 v116, v64, v64
    v_cvt_pk_bf16_f32 v117, v65, v65
    v_cvt_pk_bf16_f32 v118, v66, v66
    v_cvt_pk_bf16_f32 v119, v67, v67
    buffer_load_dwordx4 v11, s[40:43], s66 offen offset:3072  lds
    ds_write_b64 v46, v[112:113]
    ds_write_b32 v47, v114
    ds_write_b32 v48, v115
    ds_write_b16 v49, v116 offset:1024
    ds_write_b16 v49, v117 offset:1088
    ds_write_b16 v49, v118 offset:1152
    ds_write_b16 v49, v119 offset:1216
    s_lshl_b32 s60, s56, 6
    s_add_u32 s60, s60, s57
    s_lshl_b32 s60, s60, 4
    s_mov_b32 m0, s81
    s_nop 0
    buffer_load_dwordx4 v12, s[40:43], s66 offen offset:0  lds
    s_add_u32 s60, s60, 0x1000
    v_and_b32 v20, 7, v1
    v_lshl_add_u32 v20, v20, 7, s60
    v_and_b32 v21, 31, v1
    s_lshl_b32 s60, s64, 5
    v_add_u32 v21, s60, v21
    v_and_b32 v2, 7, v1
    s_lshl_b32 s60, s73, 3
    v_add_u32 v2, s60, v2
    v_cmp_gt_u32 vcc, 32, v1
    buffer_load_dwordx4 v13, s[40:43], s66 offen offset:1024  lds
    s_nop 0
    v_cndmask_b32 v21, v2, v21, vcc
    v_lshlrev_b32 v21, 4, v21
    v_add_u32 v21, 0x1000, v21
    buffer_load_dwordx4 v14, s[40:43], s66 offen offset:2048  lds
    buffer_load_dwordx4 v15, s[40:43], s66 offen offset:3072  lds
    s_mul_i32 s101, s3, 3
    buffer_load_dword v6, v53, s[4:7], s101 offen
    s_waitcnt lgkmcnt(0)
    s_waitcnt vmcnt(10)
    s_barrier
    ds_read_u16 v36, v24 offset:34560
    s_mov_b32 m0, s82
    s_nop 0
    buffer_load_dwordx4 v16, s[44:47], s67 offen offset:0  lds
    ds_read_u16 v37, v25 offset:34560
    ds_read_u16 v38, v26 offset:34560
    ds_read_u16 v39, v27 offset:34560
    ds_read_u16 v40, v28 offset:34560
    ds_read_u16 v41, v29 offset:34560
    ds_read_u16 v42, v30 offset:34560
    ds_read_u16 v43, v31 offset:34560
    ds_read_u16 v44, v32 offset:34560
    buffer_load_dwordx4 v17, s[44:47], s67 offen offset:1024  lds
    ds_read_u16 v45, v33 offset:34560
    ds_read_u16 v46, v34 offset:34560
    ds_read_u16 v112, v24 offset:42752
    ds_read_u16 v113, v25 offset:42752
    ds_read_u16 v114, v26 offset:42752
    ds_read_u16 v115, v27 offset:42752
    ds_read_u16 v116, v28 offset:42752
    ds_read_u16 v117, v29 offset:42752
    buffer_load_dwordx4 v18, s[44:47], s67 offen offset:2048  lds
    ds_read_u16 v118, v30 offset:42752
    ds_read_u16 v119, v31 offset:42752
    ds_read_u16 v120, v32 offset:42752
    ds_read_u16 v121, v33 offset:42752
    ds_read_u16 v122, v34 offset:42752
    v_bfe_u32 v2, v1, 3, 1
    v_lshlrev_b32 v3, 13, v2
    v_add_u32 v3, 68608, v3
    ds_read_b64 v[126:127], v3
    buffer_load_dwordx4 v19, s[44:47], s67 offen offset:3072  lds
    v_mul_u32_u24 v2, 16640, v2
    v_and_b32 v3, 3, v1
    v_mul_u32_u24 v4, 4160, v3
    v_add_u32 v2, v2, v4
    v_bfe_u32 v4, v1, 2, 1
    v_lshl_add_u32 v2, v4, 4, v2
    v_add_u32 v123, 114688, v2
    v_mul_u32_u24 v4, v4, v3
    s_bfe_u32 s67, s68, 0x40010
    s_lshl_b32 s66, s67, 7
    s_mul_i32 s67, s67, 229376
    v_cmp_ne_u32 s[26:27], 0, v4
    v_lshlrev_b32 v3, 4, v3
    v_sub_u32 v5, 64, v3
    v_mov_b32 v124, 0
    v_mov_b32 v125, 0
    s_waitcnt lgkmcnt(12)
    v_lshl_or_b32 v64, v37, 16, v36
    v_lshl_or_b32 v70, v38, 16, v37
    v_lshl_or_b32 v65, v39, 16, v38
    s_mov_b32 m0, s83
    s_nop 0
    buffer_load_dwordx4 v8, s[40:43], s66 offen offset:0  lds
    v_lshl_or_b32 v71, v40, 16, v39
    v_lshl_or_b32 v66, v41, 16, v40
    v_lshl_or_b32 v72, v42, 16, v41
    v_lshl_or_b32 v67, v43, 16, v42
    v_lshl_or_b32 v73, v44, 16, v43
    v_lshl_or_b32 v74, v39, 16, v38
    v_lshl_or_b32 v78, v40, 16, v39
    v_lshl_or_b32 v75, v41, 16, v40
    buffer_load_dwordx4 v9, s[40:43], s66 offen offset:1024  lds
    v_lshl_or_b32 v79, v42, 16, v41
    v_lshl_or_b32 v76, v43, 16, v42
    v_lshl_or_b32 v80, v44, 16, v43
    v_lshl_or_b32 v77, v45, 16, v44
    v_lshl_or_b32 v81, v46, 16, v45
    s_waitcnt lgkmcnt(1)
    v_lshl_or_b32 v84, v113, 16, v112
    v_lshl_or_b32 v90, v114, 16, v113
    v_lshl_or_b32 v85, v115, 16, v114
    buffer_load_dwordx4 v10, s[40:43], s66 offen offset:2048  lds
    v_lshl_or_b32 v91, v116, 16, v115
    v_lshl_or_b32 v86, v117, 16, v116
    v_lshl_or_b32 v92, v118, 16, v117
    v_lshl_or_b32 v87, v119, 16, v118
    v_lshl_or_b32 v93, v120, 16, v119
    v_lshl_or_b32 v94, v115, 16, v114
    v_lshl_or_b32 v98, v116, 16, v115
    v_lshl_or_b32 v95, v117, 16, v116
    buffer_load_dwordx4 v11, s[40:43], s66 offen offset:3072  lds
    v_lshl_or_b32 v99, v118, 16, v117
    v_lshl_or_b32 v96, v119, 16, v118
    v_lshl_or_b32 v100, v120, 16, v119
    v_lshl_or_b32 v97, v121, 16, v120
    v_lshl_or_b32 v101, v122, 16, v121
    s_waitcnt lgkmcnt(0)
    v_lshlrev_b64 v[126:127], v5, v[126:127]
    v_cndmask_b32 v126, 0, v126, s[26:27]
    v_cndmask_b32 v127, 0, v127, s[26:27]
    s_mov_b32 m0, s84
    s_nop 0
    buffer_load_dwordx4 v12, s[40:43], s66 offen offset:0  lds
    buffer_load_dwordx4 v13, s[40:43], s66 offen offset:1024  lds
    buffer_load_dwordx4 v14, s[40:43], s66 offen offset:2048  lds
    buffer_load_dwordx4 v15, s[40:43], s66 offen offset:3072  lds
    s_waitcnt lgkmcnt(0)
    s_waitcnt vmcnt(8)
    s_barrier
    s_setprio 0
    buffer_load_dword v132, v23, s[48:51], 0 offen sc1
    v_and_b32 v2, 15, v1
    s_mov_b32 m0, s85
    s_nop 0
    buffer_load_dwordx4 v16, s[44:47], s67 offen offset:0  lds
    v_lshrrev_b32 v3, 4, v1
    v_add_u32 v4, 1, v2
    buffer_load_dwordx4 v17, s[44:47], s67 offen offset:1024  lds
    v_and_b32 v5, 3, v4
    v_mul_u32_u24 v5, 4160, v5
    v_lshrrev_b32 v4, 2, v4
    buffer_load_dwordx4 v18, s[44:47], s67 offen offset:2048  lds
    v_lshl_add_u32 v5, v4, 3, v5
    v_lshl_add_u32 v5, v3, 4, v5
    s_lshr_b32 s60, s56, 1
    buffer_load_dwordx4 v19, s[44:47], s67 offen offset:3072  lds
    s_and_b32 s61, s56, 1
    s_lshl_b32 s61, s61, 8
    s_mul_i32 s62, s60, 16640
    s_bfe_u32 s67, s68, 0x40014
    s_lshl_b32 s66, s67, 7
    s_mul_i32 s67, s67, 229376
    s_add_u32 s62, s62, s61
    s_add_u32 s62, s62, 114688
    v_add_u32 v128, s62, v5
    s_mov_b32 m0, s86
    s_nop 0
    buffer_load_dwordx4 v8, s[40:43], s66 offen offset:0  lds
    v_lshlrev_b32 v4, 5, v2
    v_lshlrev_b32 v5, 4, v3
    v_sub_u32 v4, v4, v5
    buffer_load_dwordx4 v9, s[40:43], s66 offen offset:1024  lds
    s_mul_i32 s62, s60, 4608
    s_sub_u32 s62, s62, s61
    s_add_u32 s62, s62, 148304
    buffer_load_dwordx4 v10, s[40:43], s66 offen offset:2048  lds
    v_add_u32 v129, s62, v4
    v_lshl_add_u32 v27, v2, 6, v5
    s_lshl_b32 s60, s56, 13
    buffer_load_dwordx4 v11, s[40:43], s66 offen offset:3072  lds
    v_lshl_add_u32 v130, v1, 4, s60
    s_lshl_b32 s60, s56, 11
    v_lshl_add_u32 v131, v1, 4, s60
    s_mov_b32 m0, s87
    s_nop 0
    buffer_load_dwordx4 v12, s[40:43], s66 offen offset:0  lds
    buffer_load_dwordx4 v13, s[40:43], s66 offen offset:1024  lds
    buffer_load_dwordx4 v14, s[40:43], s66 offen offset:2048  lds
    buffer_load_dwordx4 v15, s[40:43], s66 offen offset:3072  lds
    s_waitcnt vmcnt(8)
    s_mov_b32 s76, 262144
L_hp3:
    v_cmp_ne_u32 vcc, s69, v132
    s_cbranch_vccz L_hp3_ok
    buffer_load_dword v132, v23, s[48:51], 0 offen sc1
    s_sub_u32 s76, s76, 1
    s_waitcnt vmcnt(0)
    s_cbranch_scc0 L_hp3
L_hp3_ok:
    s_waitcnt lgkmcnt(0)
    s_barrier
    s_lshl_b32 s60, s64, 2
    s_mov_b32 m0, s88
    s_nop 0
    buffer_load_dwordx4 v16, s[44:47], s67 offen offset:0  lds
    buffer_load_dwordx4 v17, s[44:47], s67 offen offset:1024  lds
    s_add_u32 s60, s60, s56
    buffer_load_dwordx4 v18, s[44:47], s67 offen offset:2048  lds
    buffer_load_dwordx4 v19, s[44:47], s67 offen offset:3072  lds
    s_lshl_b32 s60, s60, 9
    s_bfe_u32 s67, s68, 0x40018
    s_lshl_b32 s66, s67, 7
    s_mul_i32 s67, s67, 229376
    s_mov_b32 m0, s80
    s_nop 0
    buffer_load_dwordx4 v8, s[40:43], s66 offen offset:0  lds
    s_add_u32 s10, s60, 0x80000
    buffer_load_dwordx4 v9, s[40:43], s66 offen offset:1024  lds
    s_lshl_b32 s60, s56, 8
    buffer_load_dwordx4 v10, s[40:43], s66 offen offset:2048  lds
    buffer_load_dwordx4 v11, s[40:43], s66 offen offset:3072  lds
    s_add_u32 s11, s60, 65536
    s_mov_b32 m0, s81
    s_nop 0
    buffer_load_dwordx4 v12, s[40:43], s66 offen offset:0  lds
    buffer_load_dwordx4 v13, s[40:43], s66 offen offset:1024  lds
    v_lshlrev_b32 v53, 3, v1
    buffer_load_dwordx4 v14, s[40:43], s66 offen offset:2048  lds
    buffer_load_dwordx4 v15, s[40:43], s66 offen offset:3072  lds
    buffer_load_dwordx4 v[144:147], v54, s[48:51], s89 offen offset:0 sc1
    buffer_load_dwordx4 v[148:151], v55, s[48:51], s89 offen offset:0 sc1
    buffer_load_dwordx4 v[152:155], v54, s[48:51], s89 offen offset:1024 sc1
    buffer_load_dwordx4 v[156:159], v55, s[48:51], s89 offen offset:1024 sc1
    s_waitcnt lgkmcnt(0)
    s_waitcnt vmcnt(12)
    s_barrier
    buffer_load_dword v22, v21, s[48:51], 0 offen sc1
    s_mov_b32 m0, s82
    s_nop 0
    buffer_load_dwordx4 v16, s[44:47], s67 offen offset:0  lds
    buffer_load_dwordx4 v17, s[44:47], s67 offen offset:1024  lds
    buffer_load_dwordx4 v18, s[44:47], s67 offen offset:2048  lds
    buffer_load_dwordx4 v19, s[44:47], s67 offen offset:3072  lds
    s_bfe_u32 s67, s68, 0x4001c
    s_lshl_b32 s66, s67, 7
    s_mul_i32 s67, s67, 229376
    s_mov_b32 m0, s83
    s_nop 0
    buffer_load_dwordx4 v8, s[40:43], s66 offen offset:0  lds
    buffer_load_dwordx4 v9, s[40:43], s66 offen offset:1024  lds
    buffer_load_dwordx4 v10, s[40:43], s66 offen offset:2048  lds
    buffer_load_dwordx4 v11, s[40:43], s66 offen offset:3072  lds
    s_mov_b32 m0, s84
    s_nop 0
    buffer_load_dwordx4 v12, s[40:43], s66 offen offset:0  lds
    buffer_load_dwordx4 v13, s[40:43], s66 offen offset:1024  lds
    buffer_load_dwordx4 v14, s[40:43], s66 offen offset:2048  lds
    buffer_load_dwordx4 v15, s[40:43], s66 offen offset:3072  lds
    buffer_load_dwordx4 v[160:163], v54, s[48:51], s90 offen offset:0 sc1
    buffer_load_dwordx4 v[164:167], v55, s[48:51], s90 offen offset:0 sc1
    buffer_load_dwordx4 v[168:171], v54, s[48:51], s90 offen offset:1024 sc1
    buffer_load_dwordx4 v[172:175], v55, s[48:51], s90 offen offset:1024 sc1
    s_waitcnt vmcnt(12)
    s_mov_b32 s76, 262144
L_hp5:
    v_cmp_ne_u32 vcc, s69, v22
    s_cbranch_vccz L_hp5_ok
    buffer_load_dword v22, v21, s[48:51], 0 offen sc1
    s_sub_u32 s76, s76, 1
    s_waitcnt vmcnt(0)
    s_cbranch_scc0 L_hp5
L_hp5_ok:
    s_waitcnt lgkmcnt(0)
    s_barrier
    s_mov_b32 m0, s85
    s_nop 0
    buffer_load_dwordx4 v16, s[44:47], s67 offen offset:0  lds
    buffer_load_dwordx4 v17, s[44:47], s67 offen offset:1024  lds
    buffer_load_dwordx4 v18, s[44:47], s67 offen offset:2048  lds
    buffer_load_dwordx4 v19, s[44:47], s67 offen offset:3072  lds
    s_mov_b32 m0, s11
    s_nop 0
    buffer_load_dword v53, s[48:51], s10 offen sc1 lds
    buffer_load_dword v133, v20, s[48:51], 0 offen sc1
    buffer_load_dwordx4 v[176:179], v54, s[48:51], s91 offen offset:0 sc1
    v_lshrrev_b32 v2, 7, v0
    v_mul_u32_u24 v2, 4608, v2
    buffer_load_dwordx4 v[180:183], v55, s[48:51], s91 offen offset:0 sc1
    v_and_b32 v3, 127, v0
    buffer_load_dwordx4 v[184:187], v54, s[48:51], s91 offen offset:1024 sc1
    v_lshl_add_u32 v2, v3, 2, v2
    v_add_u32 v2, 147968, v2
    buffer_load_dwordx4 v[188:191], v55, s[48:51], s91 offen offset:1024 sc1
    v_mov_b32 v3, 0
    buffer_load_dwordx4 v[192:195], v54, s[48:51], s92 offen offset:0 sc1
    v_lshlrev_b32 v4, 2, v1
    v_and_b32 v4, 124, v4
    buffer_load_dwordx4 v[196:199], v55, s[48:51], s92 offen offset:0 sc1
    v_add_u32 v4, 157184, v4
    buffer_load_dwordx4 v[200:203], v54, s[48:51], s92 offen offset:1024 sc1
    ds_write_b32 v2, v3
    ds_write_b32 v4, v3
    buffer_load_dwordx4 v[204:207], v55, s[48:51], s92 offen offset:1024 sc1
    s_mul_i32 s60, s59, 14
    buffer_load_dwordx4 v[208:211], v54, s[48:51], s93 offen offset:0 sc1
    s_mul_i32 s61, s73, 224
    s_add_u32 s61, s61, s60
    buffer_load_dwordx4 v[212:215], v55, s[48:51], s93 offen offset:0 sc1
    s_lshl_b32 s61, s61, 10
    buffer_load_dwordx4 v[216:219], v54, s[48:51], s93 offen offset:1024 sc1
    s_add_u32 s61, s61, 0x700000
    v_lshl_add_u32 v18, v1, 4, s61
    buffer_load_dwordx4 v[220:223], v55, s[48:51], s93 offen offset:1024 sc1
    v_add_u32 v19, 114688, v18
    s_waitcnt lgkmcnt(0)
    s_waitcnt vmcnt(13)
    s_barrier
    s_waitcnt vmcnt(12)
    s_mov_b32 s76, 262144
L_hx:
    v_cmp_ne_u32 vcc, s69, v133
    s_cbranch_vccz L_hx_ok
    buffer_load_dword v133, v20, s[48:51], 0 offen sc1
    s_sub_u32 s76, s76, 1
    s_waitcnt vmcnt(0)
    s_cbranch_scc0 L_hx
L_hx_ok:
    v_lshrrev_b32 v2, 4, v1
    v_and_b32 v3, 15, v1
    v_lshlrev_b32 v4, 16, v2
    v_lshl_add_u32 v4, v3, 4, v4
    s_lshl_b32 s60, s71, 8
    s_lshl_b32 s61, s56, 19
    s_add_u32 s60, s60, s61
    s_add_u32 s60, s60, 0x100000
    s_add_u32 s61, s60, 0x40000
    buffer_load_dwordx4 v[104:107], v4, s[48:51], s60 offen sc1
    buffer_load_dwordx4 v[108:111], v4, s[48:51], s61 offen sc1
    v_bfe_u32 v3, v1, 3, 1
    v_mul_u32_u24 v3, 4608, v3
    v_lshl_add_u32 v3, v2, 7, v3
    v_and_b32 v2, 7, v1
    v_lshl_add_u32 v3, v2, 4, v3
    s_lshl_b32 s60, s56, 10
    s_add_u32 s60, s60, 148480
    v_add_u32 v47, s60, v3
    buffer_load_dwordx4 v[224:227], v54, s[48:51], s94 offen offset:0 sc1
    ds_write_b128 v35, v[64:67] offset:0
    ds_write_b128 v35, v[70:73] offset:4160
    buffer_load_dwordx4 v[228:231], v55, s[48:51], s94 offen offset:0 sc1
    ds_write_b128 v35, v[74:77] offset:8320
    buffer_load_dwordx4 v[232:235], v54, s[48:51], s94 offen offset:1024 sc1
    ds_write_b128 v35, v[78:81] offset:12480
    buffer_load_dwordx4 v[236:239], v55, s[48:51], s94 offen offset:1024 sc1
    ds_write_b128 v35, v[84:87] offset:16640
    buffer_load_dwordx4 v[240:243], v54, s[48:51], s95 offen offset:0 sc1
    ds_write_b128 v35, v[90:93] offset:20800
    buffer_load_dwordx4 v[244:247], v55, s[48:51], s95 offen offset:0 sc1
    ds_write_b128 v35, v[94:97] offset:24960
    buffer_load_dwordx4 v[248:251], v54, s[48:51], s95 offen offset:1024 sc1
    ds_write_b128 v35, v[98:101] offset:29120
    buffer_load_dwordx4 v[252:255], v55, s[48:51], s95 offen offset:1024 sc1
    ds_write_b128 v123, v[124:127]
    s_waitcnt vmcnt(8)
    ds_write_b128 v47, v[104:107]
    ds_write_b128 v47, v[108:111] offset:512
    s_lshl_b32 s60, s56, 2
    s_add_u32 s60, s60, 157184
    v_mov_b32 v20, s60
    v_mov_b32 v21, 157184
    v_mov_b32 v22, -1
    s_waitcnt lgkmcnt(0)
    ds_write_b32 v20, v22 offset:64
L_hi:
    ds_read_b128 v[136:139], v21 offset:64
    s_waitcnt lgkmcnt(0)
    v_and_b32 v136, v136, v137
    v_and_b32 v136, v136, v138
    v_and_b32 v136, v136, v139
    v_cmp_eq_u32 vcc, 0, v136
    s_cbranch_vccnz L_hi
L_conv:
    ds_read_b64 v[64:65], v128 offset:0
    ds_read_b64 v[66:67], v128 offset:8
    ds_read_b128 v[124:127], v129 offset:3776
    ds_read_b128 v[120:123], v129 offset:3264
    ds_read_b128 v[116:119], v129 offset:2752
    ds_read_b128 v[112:115], v129 offset:2240
    ds_read_b128 v[108:111], v129 offset:1728
    ds_read_b128 v[104:107], v129 offset:1216
    ds_read_b128 v[100:103], v129 offset:704
    ds_read_b128 v[96:99], v129 offset:192
    ds_read_b64 v[68:69], v128 offset:512
    ds_read_b64 v[70:71], v128 offset:520
    ds_read_b64 v[72:73], v128 offset:1024
    ds_read_b64 v[74:75], v128 offset:1032
    ds_read_b64 v[76:77], v128 offset:1536
    ds_read_b64 v[78:79], v128 offset:1544
    ds_read_b64 v[80:81], v128 offset:2048
    ds_read_b64 v[82:83], v128 offset:2056
    ds_read_b64 v[84:85], v128 offset:2560
    ds_read_b64 v[86:87], v128 offset:2568
    ds_read_b64 v[88:89], v128 offset:3072
    ds_read_b64 v[90:91], v128 offset:3080
    ds_read_b64 v[92:93], v128 offset:3584
    ds_read_b64 v[94:95], v128 offset:3592
    s_waitcnt lgkmcnt(15)
    v_mfma_f32_16x16x32_bf16 v[60:63], v[64:67], v[124:127], 0
    ds_read_b128 v[124:127], v129 offset:3712
    v_mfma_f32_16x16x32_bf16 v[56:59], v[64:67], v[120:123], 0
    v_mfma_f32_16x16x32_bf16 v[52:55], v[64:67], v[116:119], 0
    v_mfma_f32_16x16x32_bf16 v[48:51], v[64:67], v[112:115], 0
    v_mfma_f32_16x16x32_bf16 v[44:47], v[64:67], v[108:111], 0
    v_mfma_f32_16x16x32_bf16 v[40:43], v[64:67], v[104:107], 0
    v_mfma_f32_16x16x32_bf16 v[36:39], v[64:67], v[100:103], 0
    s_waitcnt lgkmcnt(15)
    v_mfma_f32_16x16x32_bf16 v[32:35], v[64:67], v[96:99], 0
    s_waitcnt lgkmcnt(13)
    v_mfma_f32_16x16x32_bf16 v[60:63], v[68:71], v[120:123], v[60:63]
    ds_read_b64 v[64:65], v128 offset:64
    ds_read_b64 v[66:67], v128 offset:72
    ds_read_b128 v[120:123], v129 offset:3200
    v_mfma_f32_16x16x32_bf16 v[56:59], v[68:71], v[116:119], v[56:59]
    v_mfma_f32_16x16x32_bf16 v[52:55], v[68:71], v[112:115], v[52:55]
    v_mfma_f32_16x16x32_bf16 v[48:51], v[68:71], v[108:111], v[48:51]
    v_mfma_f32_16x16x32_bf16 v[44:47], v[68:71], v[104:107], v[44:47]
    v_mfma_f32_16x16x32_bf16 v[40:43], v[68:71], v[100:103], v[40:43]
    v_mfma_f32_16x16x32_bf16 v[36:39], v[68:71], v[96:99], v[36:39]
    s_waitcnt lgkmcnt(14)
    v_mfma_f32_16x16x32_bf16 v[60:63], v[72:75], v[116:119], v[60:63]
    ds_read_b64 v[68:69], v128 offset:576
    ds_read_b64 v[70:71], v128 offset:584
    ds_read_b128 v[116:119], v129 offset:2688
    v_mfma_f32_16x16x32_bf16 v[56:59], v[72:75], v[112:115], v[56:59]
    v_mfma_f32_16x16x32_bf16 v[52:55], v[72:75], v[108:111], v[52:55]
    v_mfma_f32_16x16x32_bf16 v[48:51], v[72:75], v[104:107], v[48:51]
    v_mfma_f32_16x16x32_bf16 v[44:47], v[72:75], v[100:103], v[44:47]
    v_mfma_f32_16x16x32_bf16 v[40:43], v[72:75], v[96:99], v[40:43]
    s_waitcnt lgkmcnt(15)
    v_mfma_f32_16x16x32_bf16 v[60:63], v[76:79], v[112:115], v[60:63]
    ds_read_b64 v[72:73], v128 offset:1088
    ds_read_b64 v[74:75], v128 offset:1096
    ds_read_b128 v[112:115], v129 offset:2176
    v_mfma_f32_16x16x32_bf16 v[56:59], v[76:79], v[108:111], v[56:59]
    v_mfma_f32_16x16x32_bf16 v[52:55], v[76:79], v[104:107], v[52:55]
    v_mfma_f32_16x16x32_bf16 v[48:51], v[76:79], v[100:103], v[48:51]
    v_mfma_f32_16x16x32_bf16 v[44:47], v[76:79], v[96:99], v[44:47]
    s_waitcnt lgkmcnt(15)
    v_mfma_f32_16x16x32_bf16 v[60:63], v[80:83], v[108:111], v[60:63]
    ds_read_b64 v[76:77], v128 offset:1600
    ds_read_b64 v[78:79], v128 offset:1608
    ds_read_b128 v[108:111], v129 offset:1664
    v_mfma_f32_16x16x32_bf16 v[56:59], v[80:83], v[104:107], v[56:59]
    v_mfma_f32_16x16x32_bf16 v[52:55], v[80:83], v[100:103], v[52:55]
    v_mfma_f32_16x16x32_bf16 v[48:51], v[80:83], v[96:99], v[48:51]
    s_waitcnt lgkmcnt(15)
    v_mfma_f32_16x16x32_bf16 v[60:63], v[84:87], v[104:107], v[60:63]
    ds_read_b64 v[80:81], v128 offset:2112
    ds_read_b64 v[82:83], v128 offset:2120
    ds_read_b128 v[104:107], v129 offset:1152
    v_mfma_f32_16x16x32_bf16 v[56:59], v[84:87], v[100:103], v[56:59]
    v_mfma_f32_16x16x32_bf16 v[52:55], v[84:87], v[96:99], v[52:55]
    v_mfma_f32_16x16x32_bf16 v[60:63], v[88:91], v[100:103], v[60:63]
    ds_read_b64 v[84:85], v128 offset:2624
    ds_read_b64 v[86:87], v128 offset:2632
    ds_read_b128 v[100:103], v129 offset:640
    v_mfma_f32_16x16x32_bf16 v[56:59], v[88:91], v[96:99], v[56:59]
    s_waitcnt lgkmcnt(15)
    v_mfma_f32_16x16x32_bf16 v[60:63], v[92:95], v[96:99], v[60:63]
    ds_read_b64 v[88:89], v128 offset:3136
    ds_read_b64 v[90:91], v128 offset:3144
    ds_read_b128 v[96:99], v129 offset:128
    ds_read_b64 v[92:93], v128 offset:3648
    ds_read_b64 v[94:95], v128 offset:3656
    v_mfma_f32_16x16x32_bf16 v[60:63], v[64:67], v[124:127], v[60:63]
    ds_read_b128 v[124:127], v129 offset:3648
    v_mfma_f32_16x16x32_bf16 v[56:59], v[64:67], v[120:123], v[56:59]
    s_waitcnt lgkmcnt(15)
    v_mfma_f32_16x16x32_bf16 v[52:55], v[64:67], v[116:119], v[52:55]
    v_mfma_f32_16x16x32_bf16 v[48:51], v[64:67], v[112:115], v[48:51]
    s_waitcnt lgkmcnt(12)
    v_mfma_f32_16x16x32_bf16 v[44:47], v[64:67], v[108:111], v[44:47]
    s_waitcnt lgkmcnt(9)
    v_mfma_f32_16x16x32_bf16 v[40:43], v[64:67], v[104:107], v[40:43]
    s_waitcnt lgkmcnt(6)
    v_mfma_f32_16x16x32_bf16 v[36:39], v[64:67], v[100:103], v[36:39]
    s_waitcnt lgkmcnt(3)
    v_mfma_f32_16x16x32_bf16 v[32:35], v[64:67], v[96:99], v[32:35]
    v_mfma_f32_16x16x32_bf16 v[60:63], v[68:71], v[120:123], v[60:63]
    ds_read_b64 v[64:65], v128 offset:128
    ds_read_b64 v[66:67], v128 offset:136
    ds_read_b128 v[120:123], v129 offset:3136
    v_mfma_f32_16x16x32_bf16 v[56:59], v[68:71], v[116:119], v[56:59]
    v_mfma_f32_16x16x32_bf16 v[52:55], v[68:71], v[112:115], v[52:55]
    v_mfma_f32_16x16x32_bf16 v[48:51], v[68:71], v[108:111], v[48:51]
    v_mfma_f32_16x16x32_bf16 v[44:47], v[68:71], v[104:107], v[44:47]
    v_mfma_f32_16x16x32_bf16 v[40:43], v[68:71], v[100:103], v[40:43]
    v_mfma_f32_16x16x32_bf16 v[36:39], v[68:71], v[96:99], v[36:39]
    v_mfma_f32_16x16x32_bf16 v[60:63], v[72:75], v[116:119], v[60:63]
    ds_read_b64 v[68:69], v128 offset:640
    ds_read_b64 v[70:71], v128 offset:648
    ds_read_b128 v[116:119], v129 offset:2624
    v_mfma_f32_16x16x32_bf16 v[56:59], v[72:75], v[112:115], v[56:59]
    v_mfma_f32_16x16x32_bf16 v[52:55], v[72:75], v[108:111], v[52:55]
    v_mfma_f32_16x16x32_bf16 v[48:51], v[72:75], v[104:107], v[48:51]
    v_mfma_f32_16x16x32_bf16 v[44:47], v[72:75], v[100:103], v[44:47]
    v_mfma_f32_16x16x32_bf16 v[40:43], v[72:75], v[96:99], v[40:43]
    v_mfma_f32_16x16x32_bf16 v[60:63], v[76:79], v[112:115], v[60:63]
    ds_read_b64 v[72:73], v128 offset:1152
    ds_read_b64 v[74:75], v128 offset:1160
    ds_read_b128 v[112:115], v129 offset:2112
    v_mfma_f32_16x16x32_bf16 v[56:59], v[76:79], v[108:111], v[56:59]
    v_mfma_f32_16x16x32_bf16 v[52:55], v[76:79], v[104:107], v[52:55]
    v_mfma_f32_16x16x32_bf16 v[48:51], v[76:79], v[100:103], v[48:51]
    v_mfma_f32_16x16x32_bf16 v[44:47], v[76:79], v[96:99], v[44:47]
    v_mfma_f32_16x16x32_bf16 v[60:63], v[80:83], v[108:111], v[60:63]
    ds_read_b64 v[76:77], v128 offset:1664
    ds_read_b64 v[78:79], v128 offset:1672
    ds_read_b128 v[108:111], v129 offset:1600
    v_mfma_f32_16x16x32_bf16 v[56:59], v[80:83], v[104:107], v[56:59]
    v_mfma_f32_16x16x32_bf16 v[52:55], v[80:83], v[100:103], v[52:55]
    v_mfma_f32_16x16x32_bf16 v[48:51], v[80:83], v[96:99], v[48:51]
    v_mfma_f32_16x16x32_bf16 v[60:63], v[84:87], v[104:107], v[60:63]
    ds_read_b64 v[80:81], v128 offset:2176
    ds_read_b64 v[82:83], v128 offset:2184
    ds_read_b128 v[104:107], v129 offset:1088
    v_mfma_f32_16x16x32_bf16 v[56:59], v[84:87], v[100:103], v[56:59]
    v_mfma_f32_16x16x32_bf16 v[52:55], v[84:87], v[96:99], v[52:55]
    v_mfma_f32_16x16x32_bf16 v[60:63], v[88:91], v[100:103], v[60:63]
    ds_read_b64 v[84:85], v128 offset:2688
    ds_read_b64 v[86:87], v128 offset:2696
    ds_read_b128 v[100:103], v129 offset:576
    v_mfma_f32_16x16x32_bf16 v[56:59], v[88:91], v[96:99], v[56:59]
    s_waitcnt lgkmcnt(15)
    v_mfma_f32_16x16x32_bf16 v[60:63], v[92:95], v[96:99], v[60:63]
    ds_read_b64 v[88:89], v128 offset:3200
    ds_read_b64 v[90:91], v128 offset:3208
    ds_read_b128 v[96:99], v129 offset:64
    ds_read_b64 v[92:93], v128 offset:3712
    ds_read_b64 v[94:95], v128 offset:3720
    v_mfma_f32_16x16x32_bf16 v[60:63], v[64:67], v[124:127], v[60:63]
    ds_read_b128 v[124:127], v129 offset:3584
    v_mfma_f32_16x16x32_bf16 v[56:59], v[64:67], v[120:123], v[56:59]
    s_waitcnt lgkmcnt(15)
    v_mfma_f32_16x16x32_bf16 v[52:55], v[64:67], v[116:119], v[52:55]
    v_mfma_f32_16x16x32_bf16 v[48:51], v[64:67], v[112:115], v[48:51]
    s_waitcnt lgkmcnt(12)
    v_mfma_f32_16x16x32_bf16 v[44:47], v[64:67], v[108:111], v[44:47]
    s_waitcnt lgkmcnt(9)
    v_mfma_f32_16x16x32_bf16 v[40:43], v[64:67], v[104:107], v[40:43]
    s_waitcnt lgkmcnt(6)
    v_mfma_f32_16x16x32_bf16 v[36:39], v[64:67], v[100:103], v[36:39]
    s_waitcnt lgkmcnt(3)
    v_mfma_f32_16x16x32_bf16 v[32:35], v[64:67], v[96:99], v[32:35]
    v_mfma_f32_16x16x32_bf16 v[60:63], v[68:71], v[120:123], v[60:63]
    ds_read_b64 v[64:65], v128 offset:192
    ds_read_b64 v[66:67], v128 offset:200
    ds_read_b128 v[120:123], v129 offset:3072
    v_mfma_f32_16x16x32_bf16 v[56:59], v[68:71], v[116:119], v[56:59]
    v_mfma_f32_16x16x32_bf16 v[52:55], v[68:71], v[112:115], v[52:55]
    v_mfma_f32_16x16x32_bf16 v[48:51], v[68:71], v[108:111], v[48:51]
    v_mfma_f32_16x16x32_bf16 v[44:47], v[68:71], v[104:107], v[44:47]
    v_mfma_f32_16x16x32_bf16 v[40:43], v[68:71], v[100:103], v[40:43]
    v_mfma_f32_16x16x32_bf16 v[36:39], v[68:71], v[96:99], v[36:39]
    v_mfma_f32_16x16x32_bf16 v[60:63], v[72:75], v[116:119], v[60:63]
    ds_read_b64 v[68:69], v128 offset:704
    ds_read_b64 v[70:71], v128 offset:712
    ds_read_b128 v[116:119], v129 offset:2560
    v_mfma_f32_16x16x32_bf16 v[56:59], v[72:75], v[112:115], v[56:59]
    v_mfma_f32_16x16x32_bf16 v[52:55], v[72:75], v[108:111], v[52:55]
    v_mfma_f32_16x16x32_bf16 v[48:51], v[72:75], v[104:107], v[48:51]
    v_mfma_f32_16x16x32_bf16 v[44:47], v[72:75], v[100:103], v[44:47]
    v_mfma_f32_16x16x32_bf16 v[40:43], v[72:75], v[96:99], v[40:43]
    v_mfma_f32_16x16x32_bf16 v[60:63], v[76:79], v[112:115], v[60:63]
    ds_read_b64 v[72:73], v128 offset:1216
    ds_read_b64 v[74:75], v128 offset:1224
    ds_read_b128 v[112:115], v129 offset:2048
    v_mfma_f32_16x16x32_bf16 v[56:59], v[76:79], v[108:111], v[56:59]
    v_mfma_f32_16x16x32_bf16 v[52:55], v[76:79], v[104:107], v[52:55]
    v_mfma_f32_16x16x32_bf16 v[48:51], v[76:79], v[100:103], v[48:51]
    v_mfma_f32_16x16x32_bf16 v[44:47], v[76:79], v[96:99], v[44:47]
    v_mfma_f32_16x16x32_bf16 v[60:63], v[80:83], v[108:111], v[60:63]
    ds_read_b64 v[76:77], v128 offset:1728
    ds_read_b64 v[78:79], v128 offset:1736
    ds_read_b128 v[108:111], v129 offset:1536
    v_mfma_f32_16x16x32_bf16 v[56:59], v[80:83], v[104:107], v[56:59]
    v_mfma_f32_16x16x32_bf16 v[52:55], v[80:83], v[100:103], v[52:55]
    v_mfma_f32_16x16x32_bf16 v[48:51], v[80:83], v[96:99], v[48:51]
    v_mfma_f32_16x16x32_bf16 v[60:63], v[84:87], v[104:107], v[60:63]
    ds_read_b64 v[80:81], v128 offset:2240
    ds_read_b64 v[82:83], v128 offset:2248
    ds_read_b128 v[104:107], v129 offset:1024
    v_mfma_f32_16x16x32_bf16 v[56:59], v[84:87], v[100:103], v[56:59]
    v_mfma_f32_16x16x32_bf16 v[52:55], v[84:87], v[96:99], v[52:55]
    v_mfma_f32_16x16x32_bf16 v[60:63], v[88:91], v[100:103], v[60:63]
    ds_read_b64 v[84:85], v128 offset:2752
    ds_read_b64 v[86:87], v128 offset:2760
    ds_read_b128 v[100:103], v129 offset:512
    v_mfma_f32_16x16x32_bf16 v[56:59], v[88:91], v[96:99], v[56:59]
    s_waitcnt lgkmcnt(15)
    v_mfma_f32_16x16x32_bf16 v[60:63], v[92:95], v[96:99], v[60:63]
    ds_read_b64 v[88:89], v128 offset:3264
    ds_read_b64 v[90:91], v128 offset:3272
    ds_read_b128 v[96:99], v129 offset:0
    ds_read_b64 v[92:93], v128 offset:3776
    ds_read_b64 v[94:95], v128 offset:3784
    v_mfma_f32_16x16x32_bf16 v[60:63], v[64:67], v[124:127], v[60:63]
    s_lshl_b32 s60, s56, 2
    s_add_u32 s60, s60, 157184
    v_mfma_f32_16x16x32_bf16 v[56:59], v[64:67], v[120:123], v[56:59]
    v_mov_b32 v20, s60
    v_mov_b32 v21, 157184
    s_waitcnt lgkmcnt(15)
    v_mfma_f32_16x16x32_bf16 v[52:55], v[64:67], v[116:119], v[52:55]
    v_mov_b32 v22, -1
    v_mov_b32 v23, s69
    s_waitcnt lgkmcnt(14)
    v_mfma_f32_16x16x32_bf16 v[48:51], v[64:67], v[112:115], v[48:51]
    s_lshl_b32 s60, s71, 13
    s_lshl_b32 s61, s56, 11
    s_waitcnt lgkmcnt(11)
    v_mfma_f32_16x16x32_bf16 v[44:47], v[64:67], v[108:111], v[44:47]
    s_add_u32 s60, s60, s61
    s_add_u32 s63, s60, 0x300000
    s_waitcnt lgkmcnt(8)
    v_mfma_f32_16x16x32_bf16 v[40:43], v[64:67], v[104:107], v[40:43]
    s_lshl_b32 s60, s56, 8
    s_add_u32 s60, s60, s71
    s_waitcnt lgkmcnt(5)
    v_mfma_f32_16x16x32_bf16 v[36:39], v[64:67], v[100:103], v[36:39]
    s_lshl_b32 s60, s60, 5
    s_add_u32 s77, s60, 0x28000
    s_waitcnt lgkmcnt(2)
    v_mfma_f32_16x16x32_bf16 v[32:35], v[64:67], v[96:99], v[32:35]
    s_lshr_b32 s60, s73, 1
    s_lshl_b32 s60, s60, 3
    v_mfma_f32_16x16x32_bf16 v[60:63], v[68:71], v[120:123], v[60:63]
    s_add_u32 s60, s60, s59
    s_lshl_b32 s60, s60, 2
    v_mfma_f32_16x16x32_bf16 v[56:59], v[68:71], v[116:119], v[56:59]
    s_lshr_b32 s61, s74, 1
    s_add_u32 s60, s60, s61
    v_mfma_f32_16x16x32_bf16 v[52:55], v[68:71], v[112:115], v[52:55]
    s_lshl_b32 s60, s60, 7
    s_add_u32 s5, s60, 0x8000
    v_mfma_f32_16x16x32_bf16 v[48:51], v[68:71], v[108:111], v[48:51]
    s_add_u32 s7, s69, 7
    s_lshl_b32 s60, s56, 3
    v_mfma_f32_16x16x32_bf16 v[44:47], v[68:71], v[104:107], v[44:47]
    s_add_u32 s60, s60, s57
    s_lshl_b32 s60, s60, 10
    v_mfma_f32_16x16x32_bf16 v[40:43], v[68:71], v[100:103], v[40:43]
    s_add_u32 s77, s60, 0x28000
    v_mov_b32 v24, 1
    v_mfma_f32_16x16x32_bf16 v[36:39], v[68:71], v[96:99], v[36:39]
    v_lshlrev_b32 v25, 7, v1
    v_mfma_f32_16x16x32_bf16 v[60:63], v[72:75], v[116:119], v[60:63]
    ds_write_b128 v130, v[32:35] offset:0
    v_mfma_f32_16x16x32_bf16 v[56:59], v[72:75], v[112:115], v[56:59]
    v_mfma_f32_16x16x32_bf16 v[52:55], v[72:75], v[108:111], v[52:55]
    v_mfma_f32_16x16x32_bf16 v[48:51], v[72:75], v[104:107], v[48:51]
    v_mfma_f32_16x16x32_bf16 v[44:47], v[72:75], v[100:103], v[44:47]
    v_mfma_f32_16x16x32_bf16 v[40:43], v[72:75], v[96:99], v[40:43]
    v_mfma_f32_16x16x32_bf16 v[60:63], v[76:79], v[112:115], v[60:63]
    v_mfma_f32_16x16x32_bf16 v[56:59], v[76:79], v[108:111], v[56:59]
    ds_write_b128 v130, v[36:39] offset:1024
    v_mfma_f32_16x16x32_bf16 v[52:55], v[76:79], v[104:107], v[52:55]
    v_mfma_f32_16x16x32_bf16 v[48:51], v[76:79], v[100:103], v[48:51]
    v_mfma_f32_16x16x32_bf16 v[44:47], v[76:79], v[96:99], v[44:47]
    v_mfma_f32_16x16x32_bf16 v[60:63], v[80:83], v[108:111], v[60:63]
    v_mfma_f32_16x16x32_bf16 v[56:59], v[80:83], v[104:107], v[56:59]
    v_mfma_f32_16x16x32_bf16 v[52:55], v[80:83], v[100:103], v[52:55]
    ds_write_b128 v130, v[40:43] offset:2048
    v_mfma_f32_16x16x32_bf16 v[48:51], v[80:83], v[96:99], v[48:51]
    v_mfma_f32_16x16x32_bf16 v[60:63], v[84:87], v[104:107], v[60:63]
    v_mfma_f32_16x16x32_bf16 v[56:59], v[84:87], v[100:103], v[56:59]
    v_mfma_f32_16x16x32_bf16 v[52:55], v[84:87], v[96:99], v[52:55]
    v_mfma_f32_16x16x32_bf16 v[60:63], v[88:91], v[100:103], v[60:63]
    ds_write_b128 v130, v[44:47] offset:3072
    v_mfma_f32_16x16x32_bf16 v[56:59], v[88:91], v[96:99], v[56:59]
    s_waitcnt lgkmcnt(4)
    v_mfma_f32_16x16x32_bf16 v[60:63], v[92:95], v[96:99], v[60:63]
    ds_write_b128 v130, v[48:51] offset:4096
    s_nop 1
    ds_write_b128 v130, v[52:55] offset:5120
    s_nop 1
    ds_write_b128 v130, v[56:59] offset:6144
    s_nop 0
    ds_write_b128 v130, v[60:63] offset:7168
    s_waitcnt lgkmcnt(0)
    ds_write_b32 v20, v22
L_cw:
    ds_read_b128 v[64:67], v21 offset:0
    s_waitcnt lgkmcnt(0)
    v_and_b32 v64, v64, v65
    v_and_b32 v64, v64, v66
    v_and_b32 v64, v64, v67
    v_cmp_eq_u32 vcc, 0, v64
    s_cbranch_vccnz L_cw
    s_buffer_load_dword s6, s[48:51], s5 glc
    ds_read_b128 v[64:67], v131 offset:0
    ds_read_b128 v[68:71], v131 offset:8192
    ds_read_b128 v[72:75], v131 offset:16384
    ds_read_b128 v[76:79], v131 offset:24576
    ds_read_b128 v[80:83], v131 offset:1024
    ds_read_b128 v[84:87], v131 offset:9216
    ds_read_b128 v[88:91], v131 offset:17408
    ds_read_b128 v[92:95], v131 offset:25600
    s_waitcnt lgkmcnt(4)
    v_add_f32 v64, v64, v68
    v_add_f32 v65, v65, v69
    v_add_f32 v66, v66, v70
    v_add_f32 v67, v67, v71
    v_add_f32 v72, v72, v76
    v_add_f32 v73, v73, v77
    v_add_f32 v74, v74, v78
    v_add_f32 v75, v75, v79
    v_cvt_pk_bf16_f32 v32, v64, v72
    v_cvt_pk_bf16_f32 v33, v65, v73
    v_cvt_pk_bf16_f32 v34, v66, v74
    v_cvt_pk_bf16_f32 v35, v67, v75
    buffer_store_dwordx4 v[32:35], v27, s[48:51], s63 offen offset:0 sc1
    s_waitcnt lgkmcnt(0)
    v_add_f32 v80, v80, v84
    v_add_f32 v81, v81, v85
    v_add_f32 v82, v82, v86
    v_add_f32 v83, v83, v87
    v_add_f32 v88, v88, v92
    v_add_f32 v89, v89, v93
    v_add_f32 v90, v90, v94
    v_add_f32 v91, v91, v95
    v_cvt_pk_bf16_f32 v36, v80, v88
    v_cvt_pk_bf16_f32 v37, v81, v89
    v_cvt_pk_bf16_f32 v38, v82, v90
    v_cvt_pk_bf16_f32 v39, v83, v91
    buffer_store_dwordx4 v[36:39], v27, s[48:51], s63 offen offset:1024 sc1
    s_waitcnt lgkmcnt(0)
    s_cmp_lg_u32 s6, s7
    s_cbranch_scc1 L_hb
    buffer_load_dwordx4 v[32:35], v18, s[48:51], s89 offen offset:0 sc1
    buffer_load_dwordx4 v[36:39], v18, s[48:51], s89 offen offset:1024 sc1
    buffer_load_dwordx4 v[40:43], v18, s[48:51], s90 offen offset:0 sc1
    buffer_load_dwordx4 v[44:47], v18, s[48:51], s90 offen offset:1024 sc1
    buffer_load_dwordx4 v[48:51], v18, s[48:51], s91 offen offset:0 sc1
    buffer_load_dwordx4 v[52:55], v18, s[48:51], s91 offen offset:1024 sc1
    buffer_load_dwordx4 v[56:59], v18, s[48:51], s92 offen offset:0 sc1
    buffer_load_dwordx4 v[60:63], v18, s[48:51], s92 offen offset:1024 sc1
    s_waitcnt vmcnt(8)
    s_mov_b64 exec, 0xff
    buffer_atomic_add v24, v25, s[48:51], s77 offen sc1
    s_mov_b64 exec, -1
    s_branch L_hj
L_hb:
    s_waitcnt vmcnt(0)
    s_mov_b64 exec, 0xff
    buffer_atomic_add v24, v25, s[48:51], s77 offen sc1
    s_mov_b64 exec, -1
    s_waitcnt lgkmcnt(0)
    s_buffer_load_dword s6, s[48:51], s5 glc
    s_mov_b32 s76, 262144
L_hh:
    s_waitcnt lgkmcnt(0)
    s_cmp_eq_u32 s6, s7
    s_cbranch_scc1 L_hh_ok
    s_buffer_load_dword s6, s[48:51], s5 glc
    s_sub_u32 s76, s76, 1
    s_cbranch_scc0 L_hh
L_hh_ok:
    buffer_load_dwordx4 v[32:35], v18, s[48:51], s89 offen offset:0 sc1
    buffer_load_dwordx4 v[36:39], v18, s[48:51], s89 offen offset:1024 sc1
    buffer_load_dwordx4 v[40:43], v18, s[48:51], s90 offen offset:0 sc1
    buffer_load_dwordx4 v[44:47], v18, s[48:51], s90 offen offset:1024 sc1
    buffer_load_dwordx4 v[48:51], v18, s[48:51], s91 offen offset:0 sc1
    buffer_load_dwordx4 v[52:55], v18, s[48:51], s91 offen offset:1024 sc1
    buffer_load_dwordx4 v[56:59], v18, s[48:51], s92 offen offset:0 sc1
    buffer_load_dwordx4 v[60:63], v18, s[48:51], s92 offen offset:1024 sc1
L_hj:
    s_waitcnt vmcnt(7)
    v_mfma_f32_16x16x32_bf16 v[80:83], v[144:147], v[32:35], 0
    v_mfma_f32_16x16x32_bf16 v[84:87], v[148:151], v[32:35], 0
    v_mfma_f32_16x16x32_bf16 v[88:91], v[152:155], v[32:35], 0
    v_mfma_f32_16x16x32_bf16 v[92:95], v[156:159], v[32:35], 0
    buffer_load_dwordx4 v[32:35], v18, s[48:51], s93 offen offset:0 sc1
    s_waitcnt vmcnt(7)
    v_mfma_f32_16x16x32_bf16 v[108:111], v[156:159], v[36:39], 0
    v_mfma_f32_16x16x32_bf16 v[104:107], v[152:155], v[36:39], 0
    v_mfma_f32_16x16x32_bf16 v[100:103], v[148:151], v[36:39], 0
    v_mfma_f32_16x16x32_bf16 v[96:99], v[144:147], v[36:39], 0
    buffer_load_dwordx4 v[36:39], v18, s[48:51], s93 offen offset:1024 sc1
    s_waitcnt vmcnt(7)
    v_mfma_f32_16x16x32_bf16 v[80:83], v[160:163], v[40:43], v[80:83]
    v_mfma_f32_16x16x32_bf16 v[84:87], v[164:167], v[40:43], v[84:87]
    v_mfma_f32_16x16x32_bf16 v[88:91], v[168:171], v[40:43], v[88:91]
    v_mfma_f32_16x16x32_bf16 v[92:95], v[172:175], v[40:43], v[92:95]
    buffer_load_dwordx4 v[40:43], v18, s[48:51], s94 offen offset:0 sc1
    s_waitcnt vmcnt(7)
    v_mfma_f32_16x16x32_bf16 v[108:111], v[172:175], v[44:47], v[108:111]
    v_mfma_f32_16x16x32_bf16 v[104:107], v[168:171], v[44:47], v[104:107]
    v_mfma_f32_16x16x32_bf16 v[100:103], v[164:167], v[44:47], v[100:103]
    v_mfma_f32_16x16x32_bf16 v[96:99], v[160:163], v[44:47], v[96:99]
    buffer_load_dwordx4 v[44:47], v18, s[48:51], s94 offen offset:1024 sc1
    s_waitcnt vmcnt(7)
    v_mfma_f32_16x16x32_bf16 v[80:83], v[176:179], v[48:51], v[80:83]
    v_mfma_f32_16x16x32_bf16 v[84:87], v[180:183], v[48:51], v[84:87]
    v_mfma_f32_16x16x32_bf16 v[88:91], v[184:187], v[48:51], v[88:91]
    v_mfma_f32_16x16x32_bf16 v[92:95], v[188:191], v[48:51], v[92:95]
    buffer_load_dwordx4 v[48:51], v18, s[48:51], s95 offen offset:0 sc1
    s_waitcnt vmcnt(7)
    v_mfma_f32_16x16x32_bf16 v[108:111], v[188:191], v[52:55], v[108:111]
    v_mfma_f32_16x16x32_bf16 v[104:107], v[184:187], v[52:55], v[104:107]
    v_mfma_f32_16x16x32_bf16 v[100:103], v[180:183], v[52:55], v[100:103]
    v_mfma_f32_16x16x32_bf16 v[96:99], v[176:179], v[52:55], v[96:99]
    buffer_load_dwordx4 v[52:55], v18, s[48:51], s95 offen offset:1024 sc1
    s_waitcnt vmcnt(7)
    v_mfma_f32_16x16x32_bf16 v[80:83], v[192:195], v[56:59], v[80:83]
    v_mfma_f32_16x16x32_bf16 v[84:87], v[196:199], v[56:59], v[84:87]
    v_mfma_f32_16x16x32_bf16 v[88:91], v[200:203], v[56:59], v[88:91]
    v_mfma_f32_16x16x32_bf16 v[92:95], v[204:207], v[56:59], v[92:95]
    buffer_load_dwordx4 v[56:59], v19, s[48:51], s89 offen offset:0 sc1
    s_waitcnt vmcnt(7)
    v_mfma_f32_16x16x32_bf16 v[108:111], v[204:207], v[60:63], v[108:111]
    v_mfma_f32_16x16x32_bf16 v[104:107], v[200:203], v[60:63], v[104:107]
    v_mfma_f32_16x16x32_bf16 v[100:103], v[196:199], v[60:63], v[100:103]
    v_mfma_f32_16x16x32_bf16 v[96:99], v[192:195], v[60:63], v[96:99]
    buffer_load_dwordx4 v[60:63], v19, s[48:51], s89 offen offset:1024 sc1
    s_waitcnt vmcnt(7)
    v_mfma_f32_16x16x32_bf16 v[80:83], v[208:211], v[32:35], v[80:83]
    v_mfma_f32_16x16x32_bf16 v[84:87], v[212:215], v[32:35], v[84:87]
    v_mfma_f32_16x16x32_bf16 v[88:91], v[216:219], v[32:35], v[88:91]
    v_mfma_f32_16x16x32_bf16 v[92:95], v[220:223], v[32:35], v[92:95]
    buffer_load_dwordx4 v[32:35], v19, s[48:51], s90 offen offset:0 sc1
    s_waitcnt vmcnt(7)
    v_mfma_f32_16x16x32_bf16 v[108:111], v[220:223], v[36:39], v[108:111]
    v_mfma_f32_16x16x32_bf16 v[104:107], v[216:219], v[36:39], v[104:107]
    v_mfma_f32_16x16x32_bf16 v[100:103], v[212:215], v[36:39], v[100:103]
    v_mfma_f32_16x16x32_bf16 v[96:99], v[208:211], v[36:39], v[96:99]
    buffer_load_dwordx4 v[36:39], v19, s[48:51], s90 offen offset:1024 sc1
    s_waitcnt vmcnt(7)
    v_mfma_f32_16x16x32_bf16 v[80:83], v[224:227], v[40:43], v[80:83]
    v_mfma_f32_16x16x32_bf16 v[84:87], v[228:231], v[40:43], v[84:87]
    v_mfma_f32_16x16x32_bf16 v[88:91], v[232:235], v[40:43], v[88:91]
    v_mfma_f32_16x16x32_bf16 v[92:95], v[236:239], v[40:43], v[92:95]
    buffer_load_dwordx4 v[40:43], v19, s[48:51], s91 offen offset:0 sc1
    s_waitcnt vmcnt(7)
    v_mfma_f32_16x16x32_bf16 v[108:111], v[236:239], v[44:47], v[108:111]
    v_mfma_f32_16x16x32_bf16 v[104:107], v[232:235], v[44:47], v[104:107]
    v_mfma_f32_16x16x32_bf16 v[100:103], v[228:231], v[44:47], v[100:103]
    v_mfma_f32_16x16x32_bf16 v[96:99], v[224:227], v[44:47], v[96:99]
    buffer_load_dwordx4 v[44:47], v19, s[48:51], s91 offen offset:1024 sc1
    s_waitcnt vmcnt(7)
    v_mfma_f32_16x16x32_bf16 v[80:83], v[240:243], v[48:51], v[80:83]
    v_mfma_f32_16x16x32_bf16 v[84:87], v[244:247], v[48:51], v[84:87]
    v_mfma_f32_16x16x32_bf16 v[88:91], v[248:251], v[48:51], v[88:91]
    v_mfma_f32_16x16x32_bf16 v[92:95], v[252:255], v[48:51], v[92:95]
    buffer_load_dwordx4 v[48:51], v19, s[48:51], s92 offen offset:0 sc1
    s_waitcnt vmcnt(7)
    v_mfma_f32_16x16x32_bf16 v[108:111], v[252:255], v[52:55], v[108:111]
    v_mfma_f32_16x16x32_bf16 v[104:107], v[248:251], v[52:55], v[104:107]
    v_mfma_f32_16x16x32_bf16 v[100:103], v[244:247], v[52:55], v[100:103]
    v_mfma_f32_16x16x32_bf16 v[96:99], v[240:243], v[52:55], v[96:99]
    buffer_load_dwordx4 v[52:55], v19, s[48:51], s92 offen offset:1024 sc1
    s_waitcnt vmcnt(7)
    v_mfma_f32_16x16x32_bf16 v[112:115], v[144:147], v[56:59], 0
    v_mfma_f32_16x16x32_bf16 v[116:119], v[148:151], v[56:59], 0
    v_mfma_f32_16x16x32_bf16 v[120:123], v[152:155], v[56:59], 0
    v_mfma_f32_16x16x32_bf16 v[124:127], v[156:159], v[56:59], 0
    buffer_load_dwordx4 v[56:59], v19, s[48:51], s93 offen offset:0 sc1
    s_waitcnt vmcnt(7)
    v_mfma_f32_16x16x32_bf16 v[140:143], v[156:159], v[60:63], 0
    v_mfma_f32_16x16x32_bf16 v[136:139], v[152:155], v[60:63], 0
    v_mfma_f32_16x16x32_bf16 v[132:135], v[148:151], v[60:63], 0
    v_mfma_f32_16x16x32_bf16 v[128:131], v[144:147], v[60:63], 0
    buffer_load_dwordx4 v[60:63], v19, s[48:51], s93 offen offset:1024 sc1
    buffer_load_dwordx4 v[144:147], v19, s[48:51], s94 offen offset:0 sc1
    buffer_load_dwordx4 v[148:151], v19, s[48:51], s94 offen offset:1024 sc1
    buffer_load_dwordx4 v[152:155], v19, s[48:51], s95 offen offset:0 sc1
    buffer_load_dwordx4 v[156:159], v19, s[48:51], s95 offen offset:1024 sc1
    s_mul_i32 s60, s56, 8704
    s_add_u32 s60, s60, 114688
    v_and_b32 v4, 15, v1
    v_mul_u32_u24 v4, 272, v4
    v_and_b32 v5, 48, v1
    v_add3_u32 v4, v4, v5, s60
    ds_write_b128 v4, v[80:83] offset:0
    s_waitcnt vmcnt(11)
    v_mfma_f32_16x16x32_bf16 v[112:115], v[160:163], v[32:35], v[112:115]
    v_mfma_f32_16x16x32_bf16 v[116:119], v[164:167], v[32:35], v[116:119]
    v_mfma_f32_16x16x32_bf16 v[120:123], v[168:171], v[32:35], v[120:123]
    v_mfma_f32_16x16x32_bf16 v[124:127], v[172:175], v[32:35], v[124:127]
    ds_write_b128 v4, v[84:87] offset:64
    ds_write_b128 v4, v[88:91] offset:128
    ds_write_b128 v4, v[92:95] offset:192
    ds_write_b128 v4, v[96:99] offset:4352
    ds_write_b128 v4, v[100:103] offset:4416
    ds_write_b128 v4, v[104:107] offset:4480
    ds_write_b128 v4, v[108:111] offset:4544
    s_waitcnt vmcnt(10)
    v_mfma_f32_16x16x32_bf16 v[140:143], v[172:175], v[36:39], v[140:143]
    v_mfma_f32_16x16x32_bf16 v[136:139], v[168:171], v[36:39], v[136:139]
    v_mfma_f32_16x16x32_bf16 v[132:135], v[164:167], v[36:39], v[132:135]
    v_mfma_f32_16x16x32_bf16 v[128:131], v[160:163], v[36:39], v[128:131]
    s_waitcnt lgkmcnt(0)
    ds_write_b32 v20, v22 offset:16
    s_waitcnt vmcnt(9)
    v_mfma_f32_16x16x32_bf16 v[112:115], v[176:179], v[40:43], v[112:115]
    v_mfma_f32_16x16x32_bf16 v[116:119], v[180:183], v[40:43], v[116:119]
    v_mfma_f32_16x16x32_bf16 v[120:123], v[184:187], v[40:43], v[120:123]
    v_mfma_f32_16x16x32_bf16 v[124:127], v[188:191], v[40:43], v[124:127]
    s_waitcnt vmcnt(8)
    v_mfma_f32_16x16x32_bf16 v[140:143], v[188:191], v[44:47], v[140:143]
    v_mfma_f32_16x16x32_bf16 v[136:139], v[184:187], v[44:47], v[136:139]
    v_mfma_f32_16x16x32_bf16 v[132:135], v[180:183], v[44:47], v[132:135]
    v_mfma_f32_16x16x32_bf16 v[128:131], v[176:179], v[44:47], v[128:131]
    s_waitcnt vmcnt(7)
    v_mfma_f32_16x16x32_bf16 v[112:115], v[192:195], v[48:51], v[112:115]
    v_mfma_f32_16x16x32_bf16 v[116:119], v[196:199], v[48:51], v[116:119]
    v_mfma_f32_16x16x32_bf16 v[120:123], v[200:203], v[48:51], v[120:123]
    v_mfma_f32_16x16x32_bf16 v[124:127], v[204:207], v[48:51], v[124:127]
    s_waitcnt vmcnt(6)
    v_mfma_f32_16x16x32_bf16 v[140:143], v[204:207], v[52:55], v[140:143]
    v_mfma_f32_16x16x32_bf16 v[136:139], v[200:203], v[52:55], v[136:139]
    v_mfma_f32_16x16x32_bf16 v[132:135], v[196:199], v[52:55], v[132:135]
    v_mfma_f32_16x16x32_bf16 v[128:131], v[192:195], v[52:55], v[128:131]
    s_waitcnt vmcnt(5)
    v_mfma_f32_16x16x32_bf16 v[112:115], v[208:211], v[56:59], v[112:115]
    v_mfma_f32_16x16x32_bf16 v[116:119], v[212:215], v[56:59], v[116:119]
    v_mfma_f32_16x16x32_bf16 v[120:123], v[216:219], v[56:59], v[120:123]
    v_mfma_f32_16x16x32_bf16 v[124:127], v[220:223], v[56:59], v[124:127]
    s_waitcnt vmcnt(4)
    v_mfma_f32_16x16x32_bf16 v[140:143], v[220:223], v[60:63], v[140:143]
    v_mfma_f32_16x16x32_bf16 v[136:139], v[216:219], v[60:63], v[136:139]
    v_mfma_f32_16x16x32_bf16 v[132:135], v[212:215], v[60:63], v[132:135]
    v_mfma_f32_16x16x32_bf16 v[128:131], v[208:211], v[60:63], v[128:131]
    v_and_b32 v8, 31, v1
    v_lshlrev_b32 v8, 10, v8
    v_add_u32 v8, 0x28000, v8
    s_add_u32 s7, s69, 32
    s_or_b32 s60, s57, s58
    s_or_b32 s60, s60, s56
    s_cmp_eq_u32 s60, 0
    s_cbranch_scc0 L_ep1
    buffer_load_dword v10, v8, s[48:51], 0 offen sc1
L_ep1:
    s_waitcnt vmcnt(3)
    v_mfma_f32_16x16x32_bf16 v[112:115], v[224:227], v[144:147], v[112:115]
    v_mfma_f32_16x16x32_bf16 v[116:119], v[228:231], v[144:147], v[116:119]
    v_mfma_f32_16x16x32_bf16 v[120:123], v[232:235], v[144:147], v[120:123]
    v_mfma_f32_16x16x32_bf16 v[124:127], v[236:239], v[144:147], v[124:127]
    s_waitcnt vmcnt(2)
    v_mfma_f32_16x16x32_bf16 v[140:143], v[236:239], v[148:151], v[140:143]
    v_mfma_f32_16x16x32_bf16 v[136:139], v[232:235], v[148:151], v[136:139]
    v_mfma_f32_16x16x32_bf16 v[132:135], v[228:231], v[148:151], v[132:135]
    v_mfma_f32_16x16x32_bf16 v[128:131], v[224:227], v[148:151], v[128:131]
L_hw:
    ds_read_b128 v[64:67], v21 offset:16
    ds_read_b128 v[68:71], v21 offset:48
    s_waitcnt lgkmcnt(0)
    v_and_b32 v64, v64, v65
    v_and_b32 v64, v64, v66
    v_and_b32 v64, v64, v67
    v_and_b32 v64, v64, v68
    v_and_b32 v64, v64, v69
    v_and_b32 v64, v64, v70
    v_and_b32 v64, v64, v71
    v_cmp_eq_u32 vcc, 0, v64
    s_cbranch_vccnz L_hw
    s_waitcnt vmcnt(1)
    v_mfma_f32_16x16x32_bf16 v[112:115], v[240:243], v[152:155], v[112:115]
    v_mfma_f32_16x16x32_bf16 v[116:119], v[244:247], v[152:155], v[116:119]
    v_mfma_f32_16x16x32_bf16 v[120:123], v[248:251], v[152:155], v[120:123]
    v_mfma_f32_16x16x32_bf16 v[124:127], v[252:255], v[152:155], v[124:127]
    s_waitcnt vmcnt(0)
    v_mfma_f32_16x16x32_bf16 v[140:143], v[252:255], v[156:159], v[140:143]
    v_mfma_f32_16x16x32_bf16 v[136:139], v[248:251], v[156:159], v[136:139]
    v_mfma_f32_16x16x32_bf16 v[132:135], v[244:247], v[156:159], v[132:135]
    v_mfma_f32_16x16x32_bf16 v[128:131], v[240:243], v[156:159], v[128:131]
    v_subrev_u32 v4, 114688, v4
    ds_write_b128 v4, v[112:115] offset:0
    ds_write_b128 v4, v[116:119] offset:64
    ds_write_b128 v4, v[120:123] offset:128
    ds_write_b128 v4, v[124:127] offset:192
    s_nop 2
    ds_write_b128 v4, v[128:131] offset:4352
    ds_write_b128 v4, v[132:135] offset:4416
    ds_write_b128 v4, v[136:139] offset:4480
    ds_write_b128 v4, v[140:143] offset:4544
    s_waitcnt lgkmcnt(0)
    s_barrier
    s_or_b32 s60, s57, s58
    s_or_b32 s60, s60, s56
    s_cmp_eq_u32 s60, 0
    s_cbranch_scc0 L_ep2
    s_waitcnt vmcnt(0)
    s_mov_b32 s76, 262144
L_ep:
    v_cmp_ne_u32 vcc, s7, v10
    s_cbranch_vccz L_ep_ok
    buffer_load_dword v10, v8, s[48:51], 0 offen sc1
    s_sub_u32 s76, s76, 1
    s_waitcnt vmcnt(0)
    s_cbranch_scc0 L_ep
L_ep_ok:
    s_mov_b64 exec, 1
    buffer_store_dword v23, off, s[48:51], 0 sc1
    s_mov_b64 exec, -1
L_ep2:
L_end:
    s_endpgm
L_G2:
    v_min_u32 v20, 27, v1
    v_lshrrev_b32 v21, 1, v20
    s_mul_i32 s60, s58, 28
    s_lshr_b32 s61, s56, 1
    s_mul_i32 s61, s61, 14
    s_add_u32 s60, s60, s61
    v_add_u32 v21, s60, v21
    v_min_u32 v21, 767, v21
    s_lshr_b32 s61, s57, 1
    s_lshl_b32 s60, s61, 8
    s_add_u32 s60, s60, 256
    v_add_u32 v21, s60, v21
    v_and_b32 v21, 1023, v21
    s_and_b32 s60, s57, 1
    s_lshl_b32 s60, s60, 20
    v_lshl_add_u32 v21, v21, 10, s60
    v_and_b32 v20, 1, v20
    v_lshl_add_u32 v21, v20, 7, v21
    v_and_b32 v20, 31, v1
    s_lshl_b32 s60, s58, 5
    v_add_u32 v20, s60, v20
    v_mul_u32_u24 v22, 9363, v20
    v_lshrrev_b32 v22, 16, v22
    v_mul_u32_u24 v23, 7, v22
    v_sub_u32 v20, v20, v23
    v_mul_u32_u24 v22, 3584, v22
    v_lshl_add_u32 v22, v20, 7, v22
    s_mul_i32 s61, s61, 896
    v_add_u32 v22, s61, v22
    s_add_u32 s60, s56, 1
    s_bitcmp1_b32 s60, 1
    s_cselect_b64 vcc, -1, 0
    s_mov_b32 s61, 256
    s_cselect_b32 s3, 458752, s61
    v_cndmask_b32 v30, v21, v22, vcc
    s_add_u32 s60, s56, 1
    s_bitcmp1_b32 s60, 1
    s_cselect_b32 s4, s44, s40
    s_cselect_b32 s5, s45, s41
    s_cselect_b32 s6, s46, s42
    s_mov_b32 s7, 0x20000
    s_waitcnt lgkmcnt(0)
    s_mul_i32 s69, s69, 0x9e3779b1
    s_add_u32 s69, s69, 0x7f4a7c15
    s_lshl_b32 s60, s79, 7
    s_add_u32 s77, s60, 0x40000
    s_waitcnt vmcnt(12)
    ds_read_b64_tr_b16 v[48:49], v5 offset:0
    ds_read_b64_tr_b16 v[50:51], v5 offset:1024
    ds_read_b64_tr_b16 v[52:53], v5 offset:32
    ds_read_b64_tr_b16 v[54:55], v5 offset:1056
    s_waitcnt lgkmcnt(2)
    buffer_store_dwordx4 v[48:51], v3, s[48:51], s63 offen sc1
    s_add_u32 s63, s63, 114688
    s_waitcnt lgkmcnt(0)
    buffer_store_dwordx4 v[52:55], v3, s[48:51], s63 offen sc1
    s_add_u32 s63, s63, 114688
    s_mov_b32 m0, s84
    s_nop 0
    buffer_load_dwordx4 v12, s[40:43], s66 offen offset:0  lds
    buffer_load_dwordx4 v13, s[40:43], s66 offen offset:1024  lds
    buffer_load_dwordx4 v14, s[40:43], s66 offen offset:2048  lds
    buffer_load_dwordx4 v15, s[40:43], s66 offen offset:3072  lds
    s_mov_b32 m0, s85
    s_nop 0
    buffer_load_dwordx4 v16, s[44:47], s67 offen offset:0  lds
    buffer_load_dwordx4 v17, s[44:47], s67 offen offset:1024  lds
    buffer_load_dwordx4 v18, s[44:47], s67 offen offset:2048  lds
    buffer_load_dwordx4 v19, s[44:47], s67 offen offset:3072  lds
    s_mul_i32 s101, s3, 1
    buffer_load_dword v41, v30, s[4:7], s101 offen
    v_lshlrev_b32 v8, 4, v1
    v_lshrrev_b32 v2, 4, v1
    v_bfe_u32 v3, v1, 2, 2
    v_lshl_add_u32 v4, v2, 3, v3
    v_lshlrev_b32 v4, 7, v4
    v_lshrrev_b32 v3, 1, v3
    v_and_b32 v5, 1, v2
    v_lshl_add_u32 v3, v5, 1, v3
    s_and_b32 s60, s56, 1
    s_lshl_b32 s60, s60, 1
    v_xor_b32 v3, s60, v3
    v_lshl_add_u32 v4, v3, 5, v4
    v_and_b32 v3, 3, v1
    v_lshl_add_u32 v4, v3, 3, v4
    s_lshr_b32 s61, s56, 1
    s_lshl_b32 s60, s61, 12
    v_add_u32 v4, s60, v4
    v_xor_b32 v5, 0x1000, v4
    v_add_u32 v10, 81920, v4
    v_add_u32 v12, 81920, v5
    v_xor_b32 v11, 32, v10
    v_xor_b32 v13, 32, v12
    v_and_b32 v3, 15, v1
    v_bfe_u32 v4, v1, 1, 3
    v_xor_b32 v4, v2, v4
    s_lshl_b32 s60, s61, 2
    v_xor_b32 v4, s60, v4
    v_lshlrev_b32 v4, 4, v4
    v_lshl_add_u32 v4, v3, 7, v4
    s_lshl_b32 s60, s61, 14
    v_add_u32 v14, s60, v4
    v_xor_b32 v15, 64, v14
    v_add_u32 v16, 131072, v14
    v_add_u32 v17, 131072, v15
    v_lshrrev_b32 v4, 1, v2
    v_lshlrev_b32 v4, 10, v4
    v_and_b32 v5, 1, v2
    v_lshl_add_u32 v4, v5, 9, v4
    v_lshl_add_u32 v40, v3, 4, v4
    v_and_b32 v3, 3, v1
    v_mov_b32 v4, 0x3f803f80
    v_lshlrev_b32 v40, 4, v1
    v_cmp_eq_u32 vcc, 0, v3
    s_nop 1
    v_cndmask_b32 v20, 0, v4, vcc
    v_mov_b32 v21, v20
    v_mov_b32 v22, v20
    v_mov_b32 v23, v20
    v_cmp_eq_u32 vcc, 1, v3
    s_nop 1
    v_cndmask_b32 v24, 0, v4, vcc
    v_mov_b32 v25, v24
    v_mov_b32 v26, v24
    v_mov_b32 v27, v24
    v_cmp_eq_u32 vcc, 2, v3
    s_nop 1
    v_cndmask_b32 v28, 0, v4, vcc
    v_mov_b32 v29, v28
    v_mov_b32 v30, v28
    v_mov_b32 v31, v28
    v_cmp_eq_u32 vcc, 3, v3
    s_nop 1
    v_cndmask_b32 v32, 0, v4, vcc
    v_mov_b32 v33, v32
    v_mov_b32 v34, v32
    v_mov_b32 v35, v32
    v_mov_b32 v113, 0
    v_mov_b32 v115, 0
    v_mov_b32 v117, 0
    v_mov_b32 v119, 0
    v_mov_b32 v121, 0
    v_mov_b32 v123, 0
    v_mov_b32 v125, 0
    v_mov_b32 v127, 0
    s_waitcnt vmcnt(15)
    s_barrier
    ds_read_b64_tr_b16 v[48:49], v10 offset:0
    ds_read_b64_tr_b16 v[50:51], v10 offset:512
    ds_read_b128 v[80:83], v14 offset:0
    ds_read_b64_tr_b16 v[52:53], v11 offset:0
    ds_read_b64_tr_b16 v[54:55], v11 offset:512
    ds_read_b64_tr_b16 v[56:57], v10 offset:8192
    ds_read_b64_tr_b16 v[58:59], v10 offset:8704
    ds_read_b64_tr_b16 v[60:61], v11 offset:8192
    ds_read_b64_tr_b16 v[62:63], v11 offset:8704
    ds_read_b128 v[84:87], v14 offset:2048
    ds_read_b128 v[88:91], v14 offset:4096
    ds_read_b128 v[92:95], v14 offset:6144
    s_waitcnt lgkmcnt(9)
    v_mfma_f32_16x16x32_bf16 v[128:131], v[48:51], v[80:83], 0
    ds_read_b128 v[96:99], v14 offset:8192
    s_waitcnt lgkmcnt(8)
    v_mfma_f32_16x16x32_bf16 v[132:135], v[52:55], v[80:83], 0
    s_lshl_b32 s60, s64, 3
    s_waitcnt lgkmcnt(6)
    v_mfma_f32_16x16x32_bf16 v[136:139], v[56:59], v[80:83], 0
    s_lshr_b32 s61, s56, 1
    s_waitcnt lgkmcnt(4)
    v_mfma_f32_16x16x32_bf16 v[140:143], v[60:63], v[80:83], 0
    s_lshl_b32 s61, s61, 2
    s_waitcnt lgkmcnt(3)
    v_mfma_f32_16x16x32_bf16 v[156:159], v[60:63], v[84:87], 0
    ds_read_b128 v[100:103], v14 offset:10240
    v_mfma_f32_16x16x32_bf16 v[152:155], v[56:59], v[84:87], 0
    s_add_u32 s60, s60, s61
    v_mfma_f32_16x16x32_bf16 v[148:151], v[52:55], v[84:87], 0
    s_mul_i32 s60, s60, 112
    v_mfma_f32_16x16x32_bf16 v[144:147], v[48:51], v[84:87], 0
    s_lshl_b32 s61, s65, 2
    v_mfma_f32_16x16x32_bf16 v[36:39], v[20:23], v[48:51], 0
    s_waitcnt lgkmcnt(3)
    v_mfma_f32_16x16x32_bf16 v[160:163], v[48:51], v[88:91], 0
    ds_read_b128 v[104:107], v14 offset:12288
    v_mfma_f32_16x16x32_bf16 v[164:167], v[52:55], v[88:91], 0
    s_add_u32 s60, s60, s61
    v_mfma_f32_16x16x32_bf16 v[168:171], v[56:59], v[88:91], 0
    s_and_b32 s61, s56, 1
    v_mfma_f32_16x16x32_bf16 v[172:175], v[60:63], v[88:91], 0
    s_lshl_b32 s61, s61, 1
    v_mfma_f32_16x16x32_bf16 v[36:39], v[24:27], v[52:55], v[36:39]
    s_waitcnt lgkmcnt(3)
    v_mfma_f32_16x16x32_bf16 v[188:191], v[60:63], v[92:95], 0
    ds_read_b128 v[108:111], v14 offset:14336
    v_mfma_f32_16x16x32_bf16 v[184:187], v[56:59], v[92:95], 0
    s_add_u32 s60, s60, s61
    v_mfma_f32_16x16x32_bf16 v[180:183], v[52:55], v[92:95], 0
    s_lshl_b32 s60, s60, 10
    v_mfma_f32_16x16x32_bf16 v[176:179], v[48:51], v[92:95], 0
    s_add_u32 s75, s60, 0x700000
    v_mfma_f32_16x16x32_bf16 v[36:39], v[28:31], v[56:59], v[36:39]
    s_waitcnt lgkmcnt(3)
    v_mfma_f32_16x16x32_bf16 v[192:195], v[48:51], v[96:99], 0
    s_lshl_b32 s60, s56, 10
    v_lshl_add_u32 v9, v1, 4, s60
    v_mfma_f32_16x16x32_bf16 v[196:199], v[52:55], v[96:99], 0
    v_xor_b32 v6, 0x800, v9
    v_add_u32 v9, 157696, v9
    v_mfma_f32_16x16x32_bf16 v[200:203], v[56:59], v[96:99], 0
    v_add_u32 v6, 157696, v6
    v_mfma_f32_16x16x32_bf16 v[204:207], v[60:63], v[96:99], 0
    v_mfma_f32_16x16x32_bf16 v[36:39], v[32:35], v[60:63], v[36:39]
    s_waitcnt lgkmcnt(2)
    v_mfma_f32_16x16x32_bf16 v[220:223], v[60:63], v[100:103], 0
    ds_read_b64_tr_b16 v[64:65], v12 offset:0
    ds_read_b64_tr_b16 v[66:67], v12 offset:512
    v_mfma_f32_16x16x32_bf16 v[216:219], v[56:59], v[100:103], 0
    ds_read_b128 v[80:83], v15 offset:0
    ds_read_b64_tr_b16 v[68:69], v13 offset:0
    v_mfma_f32_16x16x32_bf16 v[212:215], v[52:55], v[100:103], 0
    ds_read_b64_tr_b16 v[70:71], v13 offset:512
    ds_read_b64_tr_b16 v[72:73], v12 offset:8192
    v_mfma_f32_16x16x32_bf16 v[208:211], v[48:51], v[100:103], 0
    ds_read_b64_tr_b16 v[74:75], v12 offset:8704
    ds_read_b64_tr_b16 v[76:77], v13 offset:8192
    s_waitcnt lgkmcnt(9)
    v_mfma_f32_16x16x32_bf16 v[224:227], v[48:51], v[104:107], 0
    ds_read_b64_tr_b16 v[78:79], v13 offset:8704
    v_mfma_f32_16x16x32_bf16 v[228:231], v[52:55], v[104:107], 0
    ds_read_b128 v[84:87], v15 offset:2048
    v_mfma_f32_16x16x32_bf16 v[232:235], v[56:59], v[104:107], 0
    ds_read_b128 v[88:91], v15 offset:4096
    v_mfma_f32_16x16x32_bf16 v[236:239], v[60:63], v[104:107], 0
    ds_read_b128 v[92:95], v15 offset:6144
    s_waitcnt lgkmcnt(12)
    v_mfma_f32_16x16x32_bf16 v[252:255], v[60:63], v[108:111], 0
    v_mfma_f32_16x16x32_bf16 v[248:251], v[56:59], v[108:111], 0
    v_mfma_f32_16x16x32_bf16 v[244:247], v[52:55], v[108:111], 0
    v_mfma_f32_16x16x32_bf16 v[240:243], v[48:51], v[108:111], 0
    s_waitcnt lgkmcnt(9)
    v_mfma_f32_16x16x32_bf16 v[128:131], v[64:67], v[80:83], v[128:131]
    ds_read_b128 v[96:99], v15 offset:8192
    s_waitcnt lgkmcnt(8)
    v_mfma_f32_16x16x32_bf16 v[132:135], v[68:71], v[80:83], v[132:135]
    s_waitcnt lgkmcnt(6)
    v_mfma_f32_16x16x32_bf16 v[136:139], v[72:75], v[80:83], v[136:139]
    s_waitcnt lgkmcnt(4)
    v_mfma_f32_16x16x32_bf16 v[140:143], v[76:79], v[80:83], v[140:143]
    s_waitcnt lgkmcnt(3)
    v_mfma_f32_16x16x32_bf16 v[156:159], v[76:79], v[84:87], v[156:159]
    ds_read_b128 v[100:103], v15 offset:10240
    v_mfma_f32_16x16x32_bf16 v[152:155], v[72:75], v[84:87], v[152:155]
    v_mfma_f32_16x16x32_bf16 v[148:151], v[68:71], v[84:87], v[148:151]
    v_mfma_f32_16x16x32_bf16 v[144:147], v[64:67], v[84:87], v[144:147]
    s_waitcnt lgkmcnt(3)
    v_mfma_f32_16x16x32_bf16 v[160:163], v[64:67], v[88:91], v[160:163]
    ds_read_b128 v[104:107], v15 offset:12288
    v_mfma_f32_16x16x32_bf16 v[164:167], v[68:71], v[88:91], v[164:167]
    v_mfma_f32_16x16x32_bf16 v[168:171], v[72:75], v[88:91], v[168:171]
    v_mfma_f32_16x16x32_bf16 v[172:175], v[76:79], v[88:91], v[172:175]
    s_waitcnt lgkmcnt(3)
    v_mfma_f32_16x16x32_bf16 v[188:191], v[76:79], v[92:95], v[188:191]
    ds_read_b128 v[108:111], v15 offset:14336
    v_mfma_f32_16x16x32_bf16 v[184:187], v[72:75], v[92:95], v[184:187]
    v_mfma_f32_16x16x32_bf16 v[180:183], v[68:71], v[92:95], v[180:183]
    v_mfma_f32_16x16x32_bf16 v[176:179], v[64:67], v[92:95], v[176:179]
    s_waitcnt lgkmcnt(3)
    v_mfma_f32_16x16x32_bf16 v[192:195], v[64:67], v[96:99], v[192:195]
    v_mfma_f32_16x16x32_bf16 v[196:199], v[68:71], v[96:99], v[196:199]
    v_mfma_f32_16x16x32_bf16 v[200:203], v[72:75], v[96:99], v[200:203]
    v_mfma_f32_16x16x32_bf16 v[204:207], v[76:79], v[96:99], v[204:207]
    s_waitcnt lgkmcnt(0)
    s_waitcnt vmcnt(0)
    s_barrier
    v_mfma_f32_16x16x32_bf16 v[220:223], v[76:79], v[100:103], v[220:223]
    ds_read_b64_tr_b16 v[48:49], v10 offset:16384
    ds_read_b64_tr_b16 v[50:51], v10 offset:16896
    v_mfma_f32_16x16x32_bf16 v[216:219], v[72:75], v[100:103], v[216:219]
    ds_read_b128 v[80:83], v14 offset:32768
    ds_read_b64_tr_b16 v[52:53], v11 offset:16384
    v_mfma_f32_16x16x32_bf16 v[212:215], v[68:71], v[100:103], v[212:215]
    ds_read_b64_tr_b16 v[54:55], v11 offset:16896
    ds_read_b64_tr_b16 v[56:57], v10 offset:24576
    v_mfma_f32_16x16x32_bf16 v[208:211], v[64:67], v[100:103], v[208:211]
    ds_read_b64_tr_b16 v[58:59], v10 offset:25088
    ds_read_b64_tr_b16 v[60:61], v11 offset:24576
    v_mfma_f32_16x16x32_bf16 v[224:227], v[64:67], v[104:107], v[224:227]
    ds_read_b64_tr_b16 v[62:63], v11 offset:25088
    v_mfma_f32_16x16x32_bf16 v[228:231], v[68:71], v[104:107], v[228:231]
    ds_read_b128 v[84:87], v14 offset:34816
    v_mfma_f32_16x16x32_bf16 v[232:235], v[72:75], v[104:107], v[232:235]
    ds_read_b128 v[88:91], v14 offset:36864
    v_mfma_f32_16x16x32_bf16 v[236:239], v[76:79], v[104:107], v[236:239]
    ds_read_b128 v[92:95], v14 offset:38912
    v_mfma_f32_16x16x32_bf16 v[252:255], v[76:79], v[108:111], v[252:255]
    v_mov_b32 v2, s69
    s_mov_b64 exec, 1
    buffer_store_dword v2, off, s[48:51], s77 sc1
    s_mov_b64 exec, -1
    v_mfma_f32_16x16x32_bf16 v[248:251], v[72:75], v[108:111], v[248:251]
    v_mfma_f32_16x16x32_bf16 v[244:247], v[68:71], v[108:111], v[244:247]
    v_mfma_f32_16x16x32_bf16 v[240:243], v[64:67], v[108:111], v[240:243]
    s_waitcnt lgkmcnt(9)
    v_mfma_f32_16x16x32_bf16 v[128:131], v[48:51], v[80:83], v[128:131]
    ds_read_b128 v[96:99], v14 offset:40960
    s_waitcnt lgkmcnt(8)
    v_mfma_f32_16x16x32_bf16 v[132:135], v[52:55], v[80:83], v[132:135]
    s_and_b32 s60, s57, 1
    s_waitcnt lgkmcnt(6)
    v_mfma_f32_16x16x32_bf16 v[136:139], v[56:59], v[80:83], v[136:139]
    s_lshl_b32 s60, s60, 4
    s_waitcnt lgkmcnt(4)
    v_mfma_f32_16x16x32_bf16 v[140:143], v[60:63], v[80:83], v[140:143]
    s_and_b32 s61, s57, 2
    s_waitcnt lgkmcnt(3)
    v_mfma_f32_16x16x32_bf16 v[156:159], v[60:63], v[84:87], v[156:159]
    ds_read_b128 v[100:103], v14 offset:43008
    v_mfma_f32_16x16x32_bf16 v[152:155], v[56:59], v[84:87], v[152:155]
    s_lshl_b32 s61, s61, 2
    v_mfma_f32_16x16x32_bf16 v[148:151], v[52:55], v[84:87], v[148:151]
    s_add_u32 s60, s60, s61
    v_mfma_f32_16x16x32_bf16 v[144:147], v[48:51], v[84:87], v[144:147]
    s_lshr_b32 s78, s58, 2
    v_mfma_f32_16x16x32_bf16 v[36:39], v[20:23], v[48:51], v[36:39]
    s_waitcnt lgkmcnt(3)
    v_mfma_f32_16x16x32_bf16 v[160:163], v[48:51], v[88:91], v[160:163]
    ds_read_b128 v[104:107], v14 offset:45056
    v_mfma_f32_16x16x32_bf16 v[164:167], v[52:55], v[88:91], v[164:167]
    s_add_u32 s73, s60, s78
    v_mfma_f32_16x16x32_bf16 v[168:171], v[56:59], v[88:91], v[168:171]
    s_and_b32 s60, s57, 4
    v_mfma_f32_16x16x32_bf16 v[172:175], v[60:63], v[88:91], v[172:175]
    s_and_b32 s61, s58, 3
    v_mfma_f32_16x16x32_bf16 v[36:39], v[24:27], v[52:55], v[36:39]
    s_waitcnt lgkmcnt(3)
    v_mfma_f32_16x16x32_bf16 v[188:191], v[60:63], v[92:95], v[188:191]
    ds_read_b128 v[108:111], v14 offset:47104
    v_mfma_f32_16x16x32_bf16 v[184:187], v[56:59], v[92:95], v[184:187]
    s_add_u32 s74, s60, s61
    v_mfma_f32_16x16x32_bf16 v[180:183], v[52:55], v[92:95], v[180:183]
    s_mov_b32 s89, 0
    v_mfma_f32_16x16x32_bf16 v[176:179], v[48:51], v[92:95], v[176:179]
    s_mov_b32 s90, 2048
    v_mfma_f32_16x16x32_bf16 v[36:39], v[28:31], v[56:59], v[36:39]
    s_waitcnt lgkmcnt(3)
    v_mfma_f32_16x16x32_bf16 v[192:195], v[48:51], v[96:99], v[192:195]
    s_mov_b32 s91, 4096
    s_mov_b32 s92, 6144
    v_mfma_f32_16x16x32_bf16 v[196:199], v[52:55], v[96:99], v[196:199]
    s_mov_b32 s93, 8192
    s_mov_b32 s94, 10240
    v_mfma_f32_16x16x32_bf16 v[200:203], v[56:59], v[96:99], v[200:203]
    s_mov_b32 s95, 12288
    v_mfma_f32_16x16x32_bf16 v[204:207], v[60:63], v[96:99], v[204:207]
    v_mfma_f32_16x16x32_bf16 v[36:39], v[32:35], v[60:63], v[36:39]
    s_waitcnt lgkmcnt(2)
    v_mfma_f32_16x16x32_bf16 v[220:223], v[60:63], v[100:103], v[220:223]
    ds_read_b64_tr_b16 v[64:65], v12 offset:16384
    ds_read_b64_tr_b16 v[66:67], v12 offset:16896
    v_mfma_f32_16x16x32_bf16 v[216:219], v[56:59], v[100:103], v[216:219]
    ds_read_b128 v[80:83], v15 offset:32768
    ds_read_b64_tr_b16 v[68:69], v13 offset:16384
    v_mfma_f32_16x16x32_bf16 v[212:215], v[52:55], v[100:103], v[212:215]
    ds_read_b64_tr_b16 v[70:71], v13 offset:16896
    ds_read_b64_tr_b16 v[72:73], v12 offset:24576
    v_mfma_f32_16x16x32_bf16 v[208:211], v[48:51], v[100:103], v[208:211]
    ds_read_b64_tr_b16 v[74:75], v12 offset:25088
    ds_read_b64_tr_b16 v[76:77], v13 offset:24576
    s_waitcnt lgkmcnt(9)
    v_mfma_f32_16x16x32_bf16 v[224:227], v[48:51], v[104:107], v[224:227]
    ds_read_b64_tr_b16 v[78:79], v13 offset:25088
    v_mfma_f32_16x16x32_bf16 v[228:231], v[52:55], v[104:107], v[228:231]
    ds_read_b128 v[84:87], v15 offset:34816
    v_mfma_f32_16x16x32_bf16 v[232:235], v[56:59], v[104:107], v[232:235]
    ds_read_b128 v[88:91], v15 offset:36864
    v_mfma_f32_16x16x32_bf16 v[236:239], v[60:63], v[104:107], v[236:239]
    ds_read_b128 v[92:95], v15 offset:38912
    s_waitcnt lgkmcnt(12)
    v_mfma_f32_16x16x32_bf16 v[252:255], v[60:63], v[108:111], v[252:255]
    v_mfma_f32_16x16x32_bf16 v[248:251], v[56:59], v[108:111], v[248:251]
    v_mfma_f32_16x16x32_bf16 v[244:247], v[52:55], v[108:111], v[244:247]
    v_mfma_f32_16x16x32_bf16 v[240:243], v[48:51], v[108:111], v[240:243]
    s_waitcnt lgkmcnt(9)
    v_mfma_f32_16x16x32_bf16 v[128:131], v[64:67], v[80:83], v[128:131]
    ds_read_b128 v[96:99], v15 offset:40960
    s_waitcnt lgkmcnt(8)
    v_mfma_f32_16x16x32_bf16 v[132:135], v[68:71], v[80:83], v[132:135]
    s_waitcnt lgkmcnt(6)
    v_mfma_f32_16x16x32_bf16 v[136:139], v[72:75], v[80:83], v[136:139]
    s_waitcnt lgkmcnt(4)
    v_mfma_f32_16x16x32_bf16 v[140:143], v[76:79], v[80:83], v[140:143]
    s_waitcnt lgkmcnt(3)
    v_mfma_f32_16x16x32_bf16 v[156:159], v[76:79], v[84:87], v[156:159]
    ds_read_b128 v[100:103], v15 offset:43008
    v_mfma_f32_16x16x32_bf16 v[152:155], v[72:75], v[84:87], v[152:155]
    v_mfma_f32_16x16x32_bf16 v[148:151], v[68:71], v[84:87], v[148:151]
    v_mfma_f32_16x16x32_bf16 v[144:147], v[64:67], v[84:87], v[144:147]
    s_waitcnt lgkmcnt(3)
    v_mfma_f32_16x16x32_bf16 v[160:163], v[64:67], v[88:91], v[160:163]
    ds_read_b128 v[104:107], v15 offset:45056
    v_mfma_f32_16x16x32_bf16 v[164:167], v[68:71], v[88:91], v[164:167]
    v_mfma_f32_16x16x32_bf16 v[168:171], v[72:75], v[88:91], v[168:171]
    v_mfma_f32_16x16x32_bf16 v[172:175], v[76:79], v[88:91], v[172:175]
    s_waitcnt lgkmcnt(3)
    v_mfma_f32_16x16x32_bf16 v[188:191], v[76:79], v[92:95], v[188:191]
    ds_read_b128 v[108:111], v15 offset:47104
    v_mfma_f32_16x16x32_bf16 v[184:187], v[72:75], v[92:95], v[184:187]
    v_mfma_f32_16x16x32_bf16 v[180:183], v[68:71], v[92:95], v[180:183]
    v_mfma_f32_16x16x32_bf16 v[176:179], v[64:67], v[92:95], v[176:179]
    s_waitcnt lgkmcnt(3)
    v_mfma_f32_16x16x32_bf16 v[192:195], v[64:67], v[96:99], v[192:195]
    v_mfma_f32_16x16x32_bf16 v[196:199], v[68:71], v[96:99], v[196:199]
    v_mfma_f32_16x16x32_bf16 v[200:203], v[72:75], v[96:99], v[200:203]
    v_mfma_f32_16x16x32_bf16 v[204:207], v[76:79], v[96:99], v[204:207]
    s_waitcnt lgkmcnt(0)
    s_barrier
    v_mfma_f32_16x16x32_bf16 v[220:223], v[76:79], v[100:103], v[220:223]
    ds_read_b64_tr_b16 v[48:49], v10 offset:32768
    ds_read_b64_tr_b16 v[50:51], v10 offset:33280
    v_mfma_f32_16x16x32_bf16 v[216:219], v[72:75], v[100:103], v[216:219]
    ds_read_b128 v[80:83], v16 offset:0
    ds_read_b64_tr_b16 v[52:53], v11 offset:32768
    v_mfma_f32_16x16x32_bf16 v[212:215], v[68:71], v[100:103], v[212:215]
    ds_read_b64_tr_b16 v[54:55], v11 offset:33280
    ds_read_b64_tr_b16 v[56:57], v10 offset:40960
    v_mfma_f32_16x16x32_bf16 v[208:211], v[64:67], v[100:103], v[208:211]
    ds_read_b64_tr_b16 v[58:59], v10 offset:41472
    ds_read_b64_tr_b16 v[60:61], v11 offset:40960
    v_mfma_f32_16x16x32_bf16 v[224:227], v[64:67], v[104:107], v[224:227]
    ds_read_b64_tr_b16 v[62:63], v11 offset:41472
    v_mfma_f32_16x16x32_bf16 v[228:231], v[68:71], v[104:107], v[228:231]
    ds_read_b128 v[84:87], v16 offset:2048
    v_mfma_f32_16x16x32_bf16 v[232:235], v[72:75], v[104:107], v[232:235]
    ds_read_b128 v[88:91], v16 offset:4096
    v_mfma_f32_16x16x32_bf16 v[236:239], v[76:79], v[104:107], v[236:239]
    ds_read_b128 v[92:95], v16 offset:6144
    v_mfma_f32_16x16x32_bf16 v[252:255], v[76:79], v[108:111], v[252:255]
    v_mfma_f32_16x16x32_bf16 v[248:251], v[72:75], v[108:111], v[248:251]
    v_mfma_f32_16x16x32_bf16 v[244:247], v[68:71], v[108:111], v[244:247]
    v_mfma_f32_16x16x32_bf16 v[240:243], v[64:67], v[108:111], v[240:243]
    s_waitcnt lgkmcnt(9)
    v_mfma_f32_16x16x32_bf16 v[128:131], v[48:51], v[80:83], v[128:131]
    ds_read_b128 v[96:99], v16 offset:8192
    s_waitcnt lgkmcnt(8)
    v_mfma_f32_16x16x32_bf16 v[132:135], v[52:55], v[80:83], v[132:135]
    s_waitcnt lgkmcnt(6)
    v_mfma_f32_16x16x32_bf16 v[136:139], v[56:59], v[80:83], v[136:139]
    s_waitcnt lgkmcnt(4)
    v_mfma_f32_16x16x32_bf16 v[140:143], v[60:63], v[80:83], v[140:143]
    s_waitcnt lgkmcnt(3)
    v_mfma_f32_16x16x32_bf16 v[156:159], v[60:63], v[84:87], v[156:159]
    ds_read_b128 v[100:103], v16 offset:10240
    v_mfma_f32_16x16x32_bf16 v[152:155], v[56:59], v[84:87], v[152:155]
    v_mfma_f32_16x16x32_bf16 v[148:151], v[52:55], v[84:87], v[148:151]
    v_mfma_f32_16x16x32_bf16 v[144:147], v[48:51], v[84:87], v[144:147]
    v_mfma_f32_16x16x32_bf16 v[36:39], v[20:23], v[48:51], v[36:39]
    s_waitcnt lgkmcnt(3)
    v_mfma_f32_16x16x32_bf16 v[160:163], v[48:51], v[88:91], v[160:163]
    ds_read_b128 v[104:107], v16 offset:12288
    v_mfma_f32_16x16x32_bf16 v[164:167], v[52:55], v[88:91], v[164:167]
    v_mfma_f32_16x16x32_bf16 v[168:171], v[56:59], v[88:91], v[168:171]
    v_mfma_f32_16x16x32_bf16 v[172:175], v[60:63], v[88:91], v[172:175]
    v_mfma_f32_16x16x32_bf16 v[36:39], v[24:27], v[52:55], v[36:39]
    s_waitcnt lgkmcnt(3)
    v_mfma_f32_16x16x32_bf16 v[188:191], v[60:63], v[92:95], v[188:191]
    ds_read_b128 v[108:111], v16 offset:14336
    v_mfma_f32_16x16x32_bf16 v[184:187], v[56:59], v[92:95], v[184:187]
    v_mfma_f32_16x16x32_bf16 v[180:183], v[52:55], v[92:95], v[180:183]
    v_mfma_f32_16x16x32_bf16 v[176:179], v[48:51], v[92:95], v[176:179]
    v_mfma_f32_16x16x32_bf16 v[36:39], v[28:31], v[56:59], v[36:39]
    s_waitcnt lgkmcnt(3)
    v_mfma_f32_16x16x32_bf16 v[192:195], v[48:51], v[96:99], v[192:195]
    v_mfma_f32_16x16x32_bf16 v[196:199], v[52:55], v[96:99], v[196:199]
    v_mfma_f32_16x16x32_bf16 v[200:203], v[56:59], v[96:99], v[200:203]
    v_mfma_f32_16x16x32_bf16 v[204:207], v[60:63], v[96:99], v[204:207]
    v_mfma_f32_16x16x32_bf16 v[36:39], v[32:35], v[60:63], v[36:39]
    s_waitcnt lgkmcnt(2)
    v_mfma_f32_16x16x32_bf16 v[220:223], v[60:63], v[100:103], v[220:223]
    ds_read_b64_tr_b16 v[64:65], v12 offset:32768
    ds_read_b64_tr_b16 v[66:67], v12 offset:33280
    v_mfma_f32_16x16x32_bf16 v[216:219], v[56:59], v[100:103], v[216:219]
    ds_read_b128 v[80:83], v17 offset:0
    ds_read_b64_tr_b16 v[68:69], v13 offset:32768
    v_mfma_f32_16x16x32_bf16 v[212:215], v[52:55], v[100:103], v[212:215]
    ds_read_b64_tr_b16 v[70:71], v13 offset:33280
    ds_read_b64_tr_b16 v[72:73], v12 offset:40960
    v_mfma_f32_16x16x32_bf16 v[208:211], v[48:51], v[100:103], v[208:211]
    ds_read_b64_tr_b16 v[74:75], v12 offset:41472
    ds_read_b64_tr_b16 v[76:77], v13 offset:40960
    s_waitcnt lgkmcnt(9)
    v_mfma_f32_16x16x32_bf16 v[224:227], v[48:51], v[104:107], v[224:227]
    ds_read_b64_tr_b16 v[78:79], v13 offset:41472
    v_mfma_f32_16x16x32_bf16 v[228:231], v[52:55], v[104:107], v[228:231]
    ds_read_b128 v[84:87], v17 offset:2048
    v_mfma_f32_16x16x32_bf16 v[232:235], v[56:59], v[104:107], v[232:235]
    ds_read_b128 v[88:91], v17 offset:4096
    v_mfma_f32_16x16x32_bf16 v[236:239], v[60:63], v[104:107], v[236:239]
    ds_read_b128 v[92:95], v17 offset:6144
    s_waitcnt lgkmcnt(12)
    v_mfma_f32_16x16x32_bf16 v[252:255], v[60:63], v[108:111], v[252:255]
    v_mfma_f32_16x16x32_bf16 v[248:251], v[56:59], v[108:111], v[248:251]
    v_mfma_f32_16x16x32_bf16 v[244:247], v[52:55], v[108:111], v[244:247]
    v_mfma_f32_16x16x32_bf16 v[240:243], v[48:51], v[108:111], v[240:243]
    s_waitcnt lgkmcnt(9)
    v_mfma_f32_16x16x32_bf16 v[128:131], v[64:67], v[80:83], v[128:131]
    ds_read_b128 v[96:99], v17 offset:8192
    s_waitcnt lgkmcnt(8)
    v_mfma_f32_16x16x32_bf16 v[132:135], v[68:71], v[80:83], v[132:135]
    s_waitcnt lgkmcnt(6)
    v_mfma_f32_16x16x32_bf16 v[136:139], v[72:75], v[80:83], v[136:139]
    s_waitcnt lgkmcnt(4)
    v_mfma_f32_16x16x32_bf16 v[140:143], v[76:79], v[80:83], v[140:143]
    s_waitcnt lgkmcnt(3)
    v_mfma_f32_16x16x32_bf16 v[156:159], v[76:79], v[84:87], v[156:159]
    ds_read_b128 v[100:103], v17 offset:10240
    v_mfma_f32_16x16x32_bf16 v[152:155], v[72:75], v[84:87], v[152:155]
    v_mfma_f32_16x16x32_bf16 v[148:151], v[68:71], v[84:87], v[148:151]
    v_mfma_f32_16x16x32_bf16 v[144:147], v[64:67], v[84:87], v[144:147]
    s_waitcnt lgkmcnt(3)
    v_mfma_f32_16x16x32_bf16 v[160:163], v[64:67], v[88:91], v[160:163]
    ds_read_b128 v[104:107], v17 offset:12288
    v_mfma_f32_16x16x32_bf16 v[164:167], v[68:71], v[88:91], v[164:167]
    v_mfma_f32_16x16x32_bf16 v[168:171], v[72:75], v[88:91], v[168:171]
    v_mfma_f32_16x16x32_bf16 v[172:175], v[76:79], v[88:91], v[172:175]
    s_waitcnt lgkmcnt(3)
    v_mfma_f32_16x16x32_bf16 v[188:191], v[76:79], v[92:95], v[188:191]
    ds_read_b128 v[108:111], v17 offset:14336
    v_mfma_f32_16x16x32_bf16 v[184:187], v[72:75], v[92:95], v[184:187]
    v_mfma_f32_16x16x32_bf16 v[180:183], v[68:71], v[92:95], v[180:183]
    v_mfma_f32_16x16x32_bf16 v[176:179], v[64:67], v[92:95], v[176:179]
    s_waitcnt lgkmcnt(3)
    v_mfma_f32_16x16x32_bf16 v[192:195], v[64:67], v[96:99], v[192:195]
    v_mfma_f32_16x16x32_bf16 v[196:199], v[68:71], v[96:99], v[196:199]
    v_mfma_f32_16x16x32_bf16 v[200:203], v[72:75], v[96:99], v[200:203]
    v_mfma_f32_16x16x32_bf16 v[204:207], v[76:79], v[96:99], v[204:207]
    s_waitcnt lgkmcnt(0)
    s_barrier
    v_mfma_f32_16x16x32_bf16 v[220:223], v[76:79], v[100:103], v[220:223]
    ds_read_b64_tr_b16 v[48:49], v10 offset:0
    ds_read_b64_tr_b16 v[50:51], v10 offset:512
    v_mfma_f32_16x16x32_bf16 v[216:219], v[72:75], v[100:103], v[216:219]
    ds_read_b128 v[80:83], v14 offset:0
    ds_read_b64_tr_b16 v[52:53], v11 offset:0
    v_mfma_f32_16x16x32_bf16 v[212:215], v[68:71], v[100:103], v[212:215]
    ds_read_b64_tr_b16 v[54:55], v11 offset:512
    ds_read_b64_tr_b16 v[56:57], v10 offset:8192
    v_mfma_f32_16x16x32_bf16 v[208:211], v[64:67], v[100:103], v[208:211]
    ds_read_b64_tr_b16 v[58:59], v10 offset:8704
    ds_read_b64_tr_b16 v[60:61], v11 offset:8192
    v_mfma_f32_16x16x32_bf16 v[224:227], v[64:67], v[104:107], v[224:227]
    ds_read_b64_tr_b16 v[62:63], v11 offset:8704
    v_mfma_f32_16x16x32_bf16 v[228:231], v[68:71], v[104:107], v[228:231]
    ds_read_b128 v[84:87], v14 offset:2048
    v_mfma_f32_16x16x32_bf16 v[232:235], v[72:75], v[104:107], v[232:235]
    ds_read_b128 v[88:91], v14 offset:4096
    v_mfma_f32_16x16x32_bf16 v[236:239], v[76:79], v[104:107], v[236:239]
    ds_read_b128 v[92:95], v14 offset:6144
    v_mfma_f32_16x16x32_bf16 v[252:255], v[76:79], v[108:111], v[252:255]
    v_mfma_f32_16x16x32_bf16 v[248:251], v[72:75], v[108:111], v[248:251]
    v_mfma_f32_16x16x32_bf16 v[244:247], v[68:71], v[108:111], v[244:247]
    v_mfma_f32_16x16x32_bf16 v[240:243], v[64:67], v[108:111], v[240:243]
    s_waitcnt lgkmcnt(9)
    v_mfma_f32_16x16x32_bf16 v[128:131], v[48:51], v[80:83], v[128:131]
    ds_read_b128 v[96:99], v14 offset:8192
    s_waitcnt lgkmcnt(8)
    v_mfma_f32_16x16x32_bf16 v[132:135], v[52:55], v[80:83], v[132:135]
    s_waitcnt lgkmcnt(6)
    v_mfma_f32_16x16x32_bf16 v[136:139], v[56:59], v[80:83], v[136:139]
    s_waitcnt lgkmcnt(4)
    v_mfma_f32_16x16x32_bf16 v[140:143], v[60:63], v[80:83], v[140:143]
    s_waitcnt lgkmcnt(3)
    v_mfma_f32_16x16x32_bf16 v[156:159], v[60:63], v[84:87], v[156:159]
    ds_read_b128 v[100:103], v14 offset:10240
    v_mfma_f32_16x16x32_bf16 v[152:155], v[56:59], v[84:87], v[152:155]
    v_mfma_f32_16x16x32_bf16 v[148:151], v[52:55], v[84:87], v[148:151]
    v_mfma_f32_16x16x32_bf16 v[144:147], v[48:51], v[84:87], v[144:147]
    v_mfma_f32_16x16x32_bf16 v[36:39], v[20:23], v[48:51], v[36:39]
    s_waitcnt lgkmcnt(3)
    v_mfma_f32_16x16x32_bf16 v[160:163], v[48:51], v[88:91], v[160:163]
    ds_read_b128 v[104:107], v14 offset:12288
    v_mfma_f32_16x16x32_bf16 v[164:167], v[52:55], v[88:91], v[164:167]
    v_mfma_f32_16x16x32_bf16 v[168:171], v[56:59], v[88:91], v[168:171]
    v_mfma_f32_16x16x32_bf16 v[172:175], v[60:63], v[88:91], v[172:175]
    v_mfma_f32_16x16x32_bf16 v[36:39], v[24:27], v[52:55], v[36:39]
    s_waitcnt lgkmcnt(3)
    v_mfma_f32_16x16x32_bf16 v[188:191], v[60:63], v[92:95], v[188:191]
    ds_read_b128 v[108:111], v14 offset:14336
    v_mfma_f32_16x16x32_bf16 v[184:187], v[56:59], v[92:95], v[184:187]
    v_mfma_f32_16x16x32_bf16 v[180:183], v[52:55], v[92:95], v[180:183]
    v_mfma_f32_16x16x32_bf16 v[176:179], v[48:51], v[92:95], v[176:179]
    v_mfma_f32_16x16x32_bf16 v[36:39], v[28:31], v[56:59], v[36:39]
    s_waitcnt lgkmcnt(3)
    v_mfma_f32_16x16x32_bf16 v[192:195], v[48:51], v[96:99], v[192:195]
    v_mfma_f32_16x16x32_bf16 v[196:199], v[52:55], v[96:99], v[196:199]
    v_mfma_f32_16x16x32_bf16 v[200:203], v[56:59], v[96:99], v[200:203]
    v_mfma_f32_16x16x32_bf16 v[204:207], v[60:63], v[96:99], v[204:207]
    v_mfma_f32_16x16x32_bf16 v[36:39], v[32:35], v[60:63], v[36:39]
    s_waitcnt lgkmcnt(2)
    v_mfma_f32_16x16x32_bf16 v[220:223], v[60:63], v[100:103], v[220:223]
    ds_read_b64_tr_b16 v[64:65], v12 offset:0
    ds_read_b64_tr_b16 v[66:67], v12 offset:512
    v_mfma_f32_16x16x32_bf16 v[216:219], v[56:59], v[100:103], v[216:219]
    ds_read_b128 v[80:83], v15 offset:0
    ds_read_b64_tr_b16 v[68:69], v13 offset:0
    v_mfma_f32_16x16x32_bf16 v[212:215], v[52:55], v[100:103], v[212:215]
    ds_read_b64_tr_b16 v[70:71], v13 offset:512
    ds_read_b64_tr_b16 v[72:73], v12 offset:8192
    v_mfma_f32_16x16x32_bf16 v[208:211], v[48:51], v[100:103], v[208:211]
    ds_read_b64_tr_b16 v[74:75], v12 offset:8704
    ds_read_b64_tr_b16 v[76:77], v13 offset:8192
    s_waitcnt lgkmcnt(9)
    v_mfma_f32_16x16x32_bf16 v[224:227], v[48:51], v[104:107], v[224:227]
    ds_read_b64_tr_b16 v[78:79], v13 offset:8704
    v_mfma_f32_16x16x32_bf16 v[228:231], v[52:55], v[104:107], v[228:231]
    ds_read_b128 v[84:87], v15 offset:2048
    v_mfma_f32_16x16x32_bf16 v[232:235], v[56:59], v[104:107], v[232:235]
    ds_read_b128 v[88:91], v15 offset:4096
    v_mfma_f32_16x16x32_bf16 v[236:239], v[60:63], v[104:107], v[236:239]
    ds_read_b128 v[92:95], v15 offset:6144
    s_waitcnt lgkmcnt(12)
    v_mfma_f32_16x16x32_bf16 v[252:255], v[60:63], v[108:111], v[252:255]
    v_mfma_f32_16x16x32_bf16 v[248:251], v[56:59], v[108:111], v[248:251]
    v_mfma_f32_16x16x32_bf16 v[244:247], v[52:55], v[108:111], v[244:247]
    v_mfma_f32_16x16x32_bf16 v[240:243], v[48:51], v[108:111], v[240:243]
    s_waitcnt lgkmcnt(9)
    v_mfma_f32_16x16x32_bf16 v[128:131], v[64:67], v[80:83], v[128:131]
    ds_read_b128 v[96:99], v15 offset:8192
    s_waitcnt lgkmcnt(8)
    v_mfma_f32_16x16x32_bf16 v[132:135], v[68:71], v[80:83], v[132:135]
    s_waitcnt lgkmcnt(6)
    v_mfma_f32_16x16x32_bf16 v[136:139], v[72:75], v[80:83], v[136:139]
    s_waitcnt lgkmcnt(4)
    v_mfma_f32_16x16x32_bf16 v[140:143], v[76:79], v[80:83], v[140:143]
    s_waitcnt lgkmcnt(3)
    v_mfma_f32_16x16x32_bf16 v[156:159], v[76:79], v[84:87], v[156:159]
    ds_read_b128 v[100:103], v15 offset:10240
    v_mfma_f32_16x16x32_bf16 v[152:155], v[72:75], v[84:87], v[152:155]
    v_mfma_f32_16x16x32_bf16 v[148:151], v[68:71], v[84:87], v[148:151]
    v_mfma_f32_16x16x32_bf16 v[144:147], v[64:67], v[84:87], v[144:147]
    s_waitcnt lgkmcnt(3)
    v_mfma_f32_16x16x32_bf16 v[160:163], v[64:67], v[88:91], v[160:163]
    ds_read_b128 v[104:107], v15 offset:12288
    v_mfma_f32_16x16x32_bf16 v[164:167], v[68:71], v[88:91], v[164:167]
    v_mfma_f32_16x16x32_bf16 v[168:171], v[72:75], v[88:91], v[168:171]
    v_mfma_f32_16x16x32_bf16 v[172:175], v[76:79], v[88:91], v[172:175]
    s_waitcnt lgkmcnt(3)
    v_mfma_f32_16x16x32_bf16 v[188:191], v[76:79], v[92:95], v[188:191]
    ds_read_b128 v[108:111], v15 offset:14336
    v_mfma_f32_16x16x32_bf16 v[184:187], v[72:75], v[92:95], v[184:187]
    v_mfma_f32_16x16x32_bf16 v[180:183], v[68:71], v[92:95], v[180:183]
    v_mfma_f32_16x16x32_bf16 v[176:179], v[64:67], v[92:95], v[176:179]
    s_waitcnt lgkmcnt(3)
    v_mfma_f32_16x16x32_bf16 v[192:195], v[64:67], v[96:99], v[192:195]
    v_mfma_f32_16x16x32_bf16 v[196:199], v[68:71], v[96:99], v[196:199]
    v_mfma_f32_16x16x32_bf16 v[200:203], v[72:75], v[96:99], v[200:203]
    v_mfma_f32_16x16x32_bf16 v[204:207], v[76:79], v[96:99], v[204:207]
    s_waitcnt lgkmcnt(0)
    s_barrier
    v_mfma_f32_16x16x32_bf16 v[220:223], v[76:79], v[100:103], v[220:223]
    ds_read_b64_tr_b16 v[48:49], v10 offset:16384
    ds_read_b64_tr_b16 v[50:51], v10 offset:16896
    v_mfma_f32_16x16x32_bf16 v[216:219], v[72:75], v[100:103], v[216:219]
    ds_read_b128 v[80:83], v14 offset:32768
    ds_read_b64_tr_b16 v[52:53], v11 offset:16384
    v_mfma_f32_16x16x32_bf16 v[212:215], v[68:71], v[100:103], v[212:215]
    ds_read_b64_tr_b16 v[54:55], v11 offset:16896
    ds_read_b64_tr_b16 v[56:57], v10 offset:24576
    v_mfma_f32_16x16x32_bf16 v[208:211], v[64:67], v[100:103], v[208:211]
    ds_read_b64_tr_b16 v[58:59], v10 offset:25088
    ds_read_b64_tr_b16 v[60:61], v11 offset:24576
    v_mfma_f32_16x16x32_bf16 v[224:227], v[64:67], v[104:107], v[224:227]
    ds_read_b64_tr_b16 v[62:63], v11 offset:25088
    v_mfma_f32_16x16x32_bf16 v[228:231], v[68:71], v[104:107], v[228:231]
    ds_read_b128 v[84:87], v14 offset:34816
    v_mfma_f32_16x16x32_bf16 v[232:235], v[72:75], v[104:107], v[232:235]
    ds_read_b128 v[88:91], v14 offset:36864
    v_mfma_f32_16x16x32_bf16 v[236:239], v[76:79], v[104:107], v[236:239]
    ds_read_b128 v[92:95], v14 offset:38912
    v_mfma_f32_16x16x32_bf16 v[252:255], v[76:79], v[108:111], v[252:255]
    v_mfma_f32_16x16x32_bf16 v[248:251], v[72:75], v[108:111], v[248:251]
    v_mfma_f32_16x16x32_bf16 v[244:247], v[68:71], v[108:111], v[244:247]
    v_mfma_f32_16x16x32_bf16 v[240:243], v[64:67], v[108:111], v[240:243]
    s_waitcnt lgkmcnt(9)
    v_mfma_f32_16x16x32_bf16 v[128:131], v[48:51], v[80:83], v[128:131]
    ds_read_b128 v[96:99], v14 offset:40960
    s_waitcnt lgkmcnt(8)
    v_mfma_f32_16x16x32_bf16 v[132:135], v[52:55], v[80:83], v[132:135]
    s_waitcnt lgkmcnt(6)
    v_mfma_f32_16x16x32_bf16 v[136:139], v[56:59], v[80:83], v[136:139]
    s_waitcnt lgkmcnt(4)
    v_mfma_f32_16x16x32_bf16 v[140:143], v[60:63], v[80:83], v[140:143]
    s_waitcnt lgkmcnt(3)
    v_mfma_f32_16x16x32_bf16 v[156:159], v[60:63], v[84:87], v[156:159]
    ds_read_b128 v[100:103], v14 offset:43008
    v_mfma_f32_16x16x32_bf16 v[152:155], v[56:59], v[84:87], v[152:155]
    v_mfma_f32_16x16x32_bf16 v[148:151], v[52:55], v[84:87], v[148:151]
    v_mfma_f32_16x16x32_bf16 v[144:147], v[48:51], v[84:87], v[144:147]
    v_mfma_f32_16x16x32_bf16 v[36:39], v[20:23], v[48:51], v[36:39]
    s_waitcnt lgkmcnt(3)
    v_mfma_f32_16x16x32_bf16 v[160:163], v[48:51], v[88:91], v[160:163]
    ds_read_b128 v[104:107], v14 offset:45056
    v_mfma_f32_16x16x32_bf16 v[164:167], v[52:55], v[88:91], v[164:167]
    v_mfma_f32_16x16x32_bf16 v[168:171], v[56:59], v[88:91], v[168:171]
    v_mfma_f32_16x16x32_bf16 v[172:175], v[60:63], v[88:91], v[172:175]
    v_mfma_f32_16x16x32_bf16 v[36:39], v[24:27], v[52:55], v[36:39]
    s_waitcnt lgkmcnt(3)
    v_mfma_f32_16x16x32_bf16 v[188:191], v[60:63], v[92:95], v[188:191]
    ds_read_b128 v[108:111], v14 offset:47104
    v_mfma_f32_16x16x32_bf16 v[184:187], v[56:59], v[92:95], v[184:187]
    v_mfma_f32_16x16x32_bf16 v[180:183], v[52:55], v[92:95], v[180:183]
    v_mfma_f32_16x16x32_bf16 v[176:179], v[48:51], v[92:95], v[176:179]
    v_mfma_f32_16x16x32_bf16 v[36:39], v[28:31], v[56:59], v[36:39]
    s_waitcnt lgkmcnt(3)
    v_mfma_f32_16x16x32_bf16 v[192:195], v[48:51], v[96:99], v[192:195]
    v_mfma_f32_16x16x32_bf16 v[196:199], v[52:55], v[96:99], v[196:199]
    v_mfma_f32_16x16x32_bf16 v[200:203], v[56:59], v[96:99], v[200:203]
    v_mfma_f32_16x16x32_bf16 v[204:207], v[60:63], v[96:99], v[204:207]
    v_mfma_f32_16x16x32_bf16 v[36:39], v[32:35], v[60:63], v[36:39]
    s_waitcnt lgkmcnt(2)
    v_mfma_f32_16x16x32_bf16 v[220:223], v[60:63], v[100:103], v[220:223]
    ds_read_b64_tr_b16 v[64:65], v12 offset:16384
    ds_read_b64_tr_b16 v[66:67], v12 offset:16896
    v_mfma_f32_16x16x32_bf16 v[216:219], v[56:59], v[100:103], v[216:219]
    ds_read_b128 v[80:83], v15 offset:32768
    ds_read_b64_tr_b16 v[68:69], v13 offset:16384
    v_mfma_f32_16x16x32_bf16 v[212:215], v[52:55], v[100:103], v[212:215]
    ds_read_b64_tr_b16 v[70:71], v13 offset:16896
    ds_read_b64_tr_b16 v[72:73], v12 offset:24576
    v_mfma_f32_16x16x32_bf16 v[208:211], v[48:51], v[100:103], v[208:211]
    ds_read_b64_tr_b16 v[74:75], v12 offset:25088
    ds_read_b64_tr_b16 v[76:77], v13 offset:24576
    s_waitcnt lgkmcnt(9)
    v_mfma_f32_16x16x32_bf16 v[224:227], v[48:51], v[104:107], v[224:227]
    ds_read_b64_tr_b16 v[78:79], v13 offset:25088
    v_mfma_f32_16x16x32_bf16 v[228:231], v[52:55], v[104:107], v[228:231]
    ds_read_b128 v[84:87], v15 offset:34816
    v_mfma_f32_16x16x32_bf16 v[232:235], v[56:59], v[104:107], v[232:235]
    ds_read_b128 v[88:91], v15 offset:36864
    v_mfma_f32_16x16x32_bf16 v[236:239], v[60:63], v[104:107], v[236:239]
    ds_read_b128 v[92:95], v15 offset:38912
    s_waitcnt lgkmcnt(12)
    v_mfma_f32_16x16x32_bf16 v[252:255], v[60:63], v[108:111], v[252:255]
    v_mfma_f32_16x16x32_bf16 v[248:251], v[56:59], v[108:111], v[248:251]
    v_mfma_f32_16x16x32_bf16 v[244:247], v[52:55], v[108:111], v[244:247]
    v_mfma_f32_16x16x32_bf16 v[240:243], v[48:51], v[108:111], v[240:243]
    s_waitcnt lgkmcnt(9)
    v_mfma_f32_16x16x32_bf16 v[128:131], v[64:67], v[80:83], v[128:131]
    ds_read_b128 v[96:99], v15 offset:40960
    s_waitcnt lgkmcnt(8)
    v_mfma_f32_16x16x32_bf16 v[132:135], v[68:71], v[80:83], v[132:135]
    s_waitcnt lgkmcnt(6)
    v_mfma_f32_16x16x32_bf16 v[136:139], v[72:75], v[80:83], v[136:139]
    s_waitcnt lgkmcnt(4)
    v_mfma_f32_16x16x32_bf16 v[140:143], v[76:79], v[80:83], v[140:143]
    s_waitcnt lgkmcnt(3)
    v_mfma_f32_16x16x32_bf16 v[156:159], v[76:79], v[84:87], v[156:159]
    ds_read_b128 v[100:103], v15 offset:43008
    v_mfma_f32_16x16x32_bf16 v[152:155], v[72:75], v[84:87], v[152:155]
    v_mfma_f32_16x16x32_bf16 v[148:151], v[68:71], v[84:87], v[148:151]
    v_mfma_f32_16x16x32_bf16 v[144:147], v[64:67], v[84:87], v[144:147]
    s_waitcnt lgkmcnt(3)
    v_mfma_f32_16x16x32_bf16 v[160:163], v[64:67], v[88:91], v[160:163]
    ds_read_b128 v[104:107], v15 offset:45056
    v_mfma_f32_16x16x32_bf16 v[164:167], v[68:71], v[88:91], v[164:167]
    v_mfma_f32_16x16x32_bf16 v[168:171], v[72:75], v[88:91], v[168:171]
    v_mfma_f32_16x16x32_bf16 v[172:175], v[76:79], v[88:91], v[172:175]
    s_waitcnt lgkmcnt(3)
    v_mfma_f32_16x16x32_bf16 v[188:191], v[76:79], v[92:95], v[188:191]
    ds_read_b128 v[108:111], v15 offset:47104
    v_mfma_f32_16x16x32_bf16 v[184:187], v[72:75], v[92:95], v[184:187]
    v_mfma_f32_16x16x32_bf16 v[180:183], v[68:71], v[92:95], v[180:183]
    v_mfma_f32_16x16x32_bf16 v[176:179], v[64:67], v[92:95], v[176:179]
    s_waitcnt lgkmcnt(3)
    v_mfma_f32_16x16x32_bf16 v[192:195], v[64:67], v[96:99], v[192:195]
    v_mfma_f32_16x16x32_bf16 v[196:199], v[68:71], v[96:99], v[196:199]
    v_mfma_f32_16x16x32_bf16 v[200:203], v[72:75], v[96:99], v[200:203]
    v_mfma_f32_16x16x32_bf16 v[204:207], v[76:79], v[96:99], v[204:207]
    s_waitcnt lgkmcnt(0)
    s_barrier
    v_mfma_f32_16x16x32_bf16 v[220:223], v[76:79], v[100:103], v[220:223]
    ds_read_b64_tr_b16 v[48:49], v10 offset:32768
    ds_read_b64_tr_b16 v[50:51], v10 offset:33280
    v_mfma_f32_16x16x32_bf16 v[216:219], v[72:75], v[100:103], v[216:219]
    ds_read_b128 v[80:83], v16 offset:0
    ds_read_b64_tr_b16 v[52:53], v11 offset:32768
    v_mfma_f32_16x16x32_bf16 v[212:215], v[68:71], v[100:103], v[212:215]
    ds_read_b64_tr_b16 v[54:55], v11 offset:33280
    ds_read_b64_tr_b16 v[56:57], v10 offset:40960
    v_mfma_f32_16x16x32_bf16 v[208:211], v[64:67], v[100:103], v[208:211]
    ds_read_b64_tr_b16 v[58:59], v10 offset:41472
    ds_read_b64_tr_b16 v[60:61], v11 offset:40960
    v_mfma_f32_16x16x32_bf16 v[224:227], v[64:67], v[104:107], v[224:227]
    ds_read_b64_tr_b16 v[62:63], v11 offset:41472
    v_mfma_f32_16x16x32_bf16 v[228:231], v[68:71], v[104:107], v[228:231]
    ds_read_b128 v[84:87], v16 offset:2048
    v_mfma_f32_16x16x32_bf16 v[232:235], v[72:75], v[104:107], v[232:235]
    ds_read_b128 v[88:91], v16 offset:4096
    v_mfma_f32_16x16x32_bf16 v[236:239], v[76:79], v[104:107], v[236:239]
    ds_read_b128 v[92:95], v16 offset:6144
    v_mfma_f32_16x16x32_bf16 v[252:255], v[76:79], v[108:111], v[252:255]
    v_mfma_f32_16x16x32_bf16 v[248:251], v[72:75], v[108:111], v[248:251]
    v_mfma_f32_16x16x32_bf16 v[244:247], v[68:71], v[108:111], v[244:247]
    v_mfma_f32_16x16x32_bf16 v[240:243], v[64:67], v[108:111], v[240:243]
    s_waitcnt lgkmcnt(9)
    v_mfma_f32_16x16x32_bf16 v[128:131], v[48:51], v[80:83], v[128:131]
    ds_read_b128 v[96:99], v16 offset:8192
    s_waitcnt lgkmcnt(8)
    v_mfma_f32_16x16x32_bf16 v[132:135], v[52:55], v[80:83], v[132:135]
    s_waitcnt lgkmcnt(6)
    v_mfma_f32_16x16x32_bf16 v[136:139], v[56:59], v[80:83], v[136:139]
    s_waitcnt lgkmcnt(4)
    v_mfma_f32_16x16x32_bf16 v[140:143], v[60:63], v[80:83], v[140:143]
    s_waitcnt lgkmcnt(3)
    v_mfma_f32_16x16x32_bf16 v[156:159], v[60:63], v[84:87], v[156:159]
    ds_read_b128 v[100:103], v16 offset:10240
    v_mfma_f32_16x16x32_bf16 v[152:155], v[56:59], v[84:87], v[152:155]
    v_mfma_f32_16x16x32_bf16 v[148:151], v[52:55], v[84:87], v[148:151]
    v_mfma_f32_16x16x32_bf16 v[144:147], v[48:51], v[84:87], v[144:147]
    v_mfma_f32_16x16x32_bf16 v[36:39], v[20:23], v[48:51], v[36:39]
    s_waitcnt lgkmcnt(3)
    v_mfma_f32_16x16x32_bf16 v[160:163], v[48:51], v[88:91], v[160:163]
    ds_read_b128 v[104:107], v16 offset:12288
    v_mfma_f32_16x16x32_bf16 v[164:167], v[52:55], v[88:91], v[164:167]
    v_mfma_f32_16x16x32_bf16 v[168:171], v[56:59], v[88:91], v[168:171]
    v_mfma_f32_16x16x32_bf16 v[172:175], v[60:63], v[88:91], v[172:175]
    v_mfma_f32_16x16x32_bf16 v[36:39], v[24:27], v[52:55], v[36:39]
    s_waitcnt lgkmcnt(3)
    v_mfma_f32_16x16x32_bf16 v[188:191], v[60:63], v[92:95], v[188:191]
    ds_read_b128 v[108:111], v16 offset:14336
    v_mfma_f32_16x16x32_bf16 v[184:187], v[56:59], v[92:95], v[184:187]
    v_mfma_f32_16x16x32_bf16 v[180:183], v[52:55], v[92:95], v[180:183]
    v_mfma_f32_16x16x32_bf16 v[176:179], v[48:51], v[92:95], v[176:179]
    v_mfma_f32_16x16x32_bf16 v[36:39], v[28:31], v[56:59], v[36:39]
    s_waitcnt lgkmcnt(3)
    v_mfma_f32_16x16x32_bf16 v[192:195], v[48:51], v[96:99], v[192:195]
    v_mfma_f32_16x16x32_bf16 v[196:199], v[52:55], v[96:99], v[196:199]
    v_mfma_f32_16x16x32_bf16 v[200:203], v[56:59], v[96:99], v[200:203]
    v_mfma_f32_16x16x32_bf16 v[204:207], v[60:63], v[96:99], v[204:207]
    v_mfma_f32_16x16x32_bf16 v[36:39], v[32:35], v[60:63], v[36:39]
    s_waitcnt lgkmcnt(2)
    v_mfma_f32_16x16x32_bf16 v[220:223], v[60:63], v[100:103], v[220:223]
    ds_read_b64_tr_b16 v[64:65], v12 offset:32768
    ds_read_b64_tr_b16 v[66:67], v12 offset:33280
    v_mfma_f32_16x16x32_bf16 v[216:219], v[56:59], v[100:103], v[216:219]
    ds_read_b128 v[80:83], v17 offset:0
    ds_read_b64_tr_b16 v[68:69], v13 offset:32768
    v_mfma_f32_16x16x32_bf16 v[212:215], v[52:55], v[100:103], v[212:215]
    ds_read_b64_tr_b16 v[70:71], v13 offset:33280
    ds_read_b64_tr_b16 v[72:73], v12 offset:40960
    v_mfma_f32_16x16x32_bf16 v[208:211], v[48:51], v[100:103], v[208:211]
    ds_read_b64_tr_b16 v[74:75], v12 offset:41472
    ds_read_b64_tr_b16 v[76:77], v13 offset:40960
    s_waitcnt lgkmcnt(9)
    v_mfma_f32_16x16x32_bf16 v[224:227], v[48:51], v[104:107], v[224:227]
    ds_read_b64_tr_b16 v[78:79], v13 offset:41472
    v_mfma_f32_16x16x32_bf16 v[228:231], v[52:55], v[104:107], v[228:231]
    ds_read_b128 v[84:87], v17 offset:2048
    v_mfma_f32_16x16x32_bf16 v[232:235], v[56:59], v[104:107], v[232:235]
    ds_read_b128 v[88:91], v17 offset:4096
    v_mfma_f32_16x16x32_bf16 v[236:239], v[60:63], v[104:107], v[236:239]
    ds_read_b128 v[92:95], v17 offset:6144
    s_waitcnt lgkmcnt(12)
    v_mfma_f32_16x16x32_bf16 v[252:255], v[60:63], v[108:111], v[252:255]
    v_mfma_f32_16x16x32_bf16 v[248:251], v[56:59], v[108:111], v[248:251]
    v_mfma_f32_16x16x32_bf16 v[244:247], v[52:55], v[108:111], v[244:247]
    v_mfma_f32_16x16x32_bf16 v[240:243], v[48:51], v[108:111], v[240:243]
    s_waitcnt lgkmcnt(9)
    v_mfma_f32_16x16x32_bf16 v[128:131], v[64:67], v[80:83], v[128:131]
    ds_read_b128 v[96:99], v17 offset:8192
    s_waitcnt lgkmcnt(8)
    v_mfma_f32_16x16x32_bf16 v[132:135], v[68:71], v[80:83], v[132:135]
    s_waitcnt lgkmcnt(6)
    v_mfma_f32_16x16x32_bf16 v[136:139], v[72:75], v[80:83], v[136:139]
    s_waitcnt lgkmcnt(4)
    v_mfma_f32_16x16x32_bf16 v[140:143], v[76:79], v[80:83], v[140:143]
    s_waitcnt lgkmcnt(3)
    v_mfma_f32_16x16x32_bf16 v[156:159], v[76:79], v[84:87], v[156:159]
    ds_read_b128 v[100:103], v17 offset:10240
    v_mfma_f32_16x16x32_bf16 v[152:155], v[72:75], v[84:87], v[152:155]
    v_mfma_f32_16x16x32_bf16 v[148:151], v[68:71], v[84:87], v[148:151]
    v_mfma_f32_16x16x32_bf16 v[144:147], v[64:67], v[84:87], v[144:147]
    s_waitcnt lgkmcnt(3)
    v_mfma_f32_16x16x32_bf16 v[160:163], v[64:67], v[88:91], v[160:163]
    ds_read_b128 v[104:107], v17 offset:12288
    v_mfma_f32_16x16x32_bf16 v[164:167], v[68:71], v[88:91], v[164:167]
    v_mfma_f32_16x16x32_bf16 v[168:171], v[72:75], v[88:91], v[168:171]
    v_mfma_f32_16x16x32_bf16 v[172:175], v[76:79], v[88:91], v[172:175]
    s_waitcnt lgkmcnt(3)
    v_mfma_f32_16x16x32_bf16 v[188:191], v[76:79], v[92:95], v[188:191]
    ds_read_b128 v[108:111], v17 offset:14336
    v_mfma_f32_16x16x32_bf16 v[184:187], v[72:75], v[92:95], v[184:187]
    v_mfma_f32_16x16x32_bf16 v[180:183], v[68:71], v[92:95], v[180:183]
    v_mfma_f32_16x16x32_bf16 v[176:179], v[64:67], v[92:95], v[176:179]
    s_waitcnt lgkmcnt(3)
    v_mfma_f32_16x16x32_bf16 v[192:195], v[64:67], v[96:99], v[192:195]
    v_mfma_f32_16x16x32_bf16 v[196:199], v[68:71], v[96:99], v[196:199]
    v_mfma_f32_16x16x32_bf16 v[200:203], v[72:75], v[96:99], v[200:203]
    v_mfma_f32_16x16x32_bf16 v[204:207], v[76:79], v[96:99], v[204:207]
    s_waitcnt lgkmcnt(0)
    s_barrier
    v_mfma_f32_16x16x32_bf16 v[220:223], v[76:79], v[100:103], v[220:223]
    ds_read_b64_tr_b16 v[48:49], v10 offset:0
    ds_read_b64_tr_b16 v[50:51], v10 offset:512
    v_mfma_f32_16x16x32_bf16 v[216:219], v[72:75], v[100:103], v[216:219]
    ds_read_b128 v[80:83], v14 offset:0
    ds_read_b64_tr_b16 v[52:53], v11 offset:0
    v_mfma_f32_16x16x32_bf16 v[212:215], v[68:71], v[100:103], v[212:215]
    ds_read_b64_tr_b16 v[54:55], v11 offset:512
    ds_read_b64_tr_b16 v[56:57], v10 offset:8192
    v_mfma_f32_16x16x32_bf16 v[208:211], v[64:67], v[100:103], v[208:211]
    ds_read_b64_tr_b16 v[58:59], v10 offset:8704
    ds_read_b64_tr_b16 v[60:61], v11 offset:8192
    v_mfma_f32_16x16x32_bf16 v[224:227], v[64:67], v[104:107], v[224:227]
    ds_read_b64_tr_b16 v[62:63], v11 offset:8704
    v_mfma_f32_16x16x32_bf16 v[228:231], v[68:71], v[104:107], v[228:231]
    ds_read_b128 v[84:87], v14 offset:2048
    v_mfma_f32_16x16x32_bf16 v[232:235], v[72:75], v[104:107], v[232:235]
    ds_read_b128 v[88:91], v14 offset:4096
    v_mfma_f32_16x16x32_bf16 v[236:239], v[76:79], v[104:107], v[236:239]
    ds_read_b128 v[92:95], v14 offset:6144
    v_mfma_f32_16x16x32_bf16 v[252:255], v[76:79], v[108:111], v[252:255]
    v_mfma_f32_16x16x32_bf16 v[248:251], v[72:75], v[108:111], v[248:251]
    v_mfma_f32_16x16x32_bf16 v[244:247], v[68:71], v[108:111], v[244:247]
    v_mfma_f32_16x16x32_bf16 v[240:243], v[64:67], v[108:111], v[240:243]
    s_waitcnt lgkmcnt(9)
    v_mfma_f32_16x16x32_bf16 v[128:131], v[48:51], v[80:83], v[128:131]
    ds_read_b128 v[96:99], v14 offset:8192
    s_waitcnt lgkmcnt(8)
    v_mfma_f32_16x16x32_bf16 v[132:135], v[52:55], v[80:83], v[132:135]
    s_mul_i32 s60, s59, 14
    s_waitcnt lgkmcnt(6)
    v_mfma_f32_16x16x32_bf16 v[136:139], v[56:59], v[80:83], v[136:139]
    s_mul_i32 s61, s73, 224
    s_waitcnt lgkmcnt(4)
    v_mfma_f32_16x16x32_bf16 v[140:143], v[60:63], v[80:83], v[140:143]
    s_add_u32 s61, s61, s60
    s_waitcnt lgkmcnt(3)
    v_mfma_f32_16x16x32_bf16 v[156:159], v[60:63], v[84:87], v[156:159]
    ds_read_b128 v[100:103], v14 offset:10240
    v_mfma_f32_16x16x32_bf16 v[152:155], v[56:59], v[84:87], v[152:155]
    s_lshl_b32 s61, s61, 10
    v_mfma_f32_16x16x32_bf16 v[148:151], v[52:55], v[84:87], v[148:151]
    s_add_u32 s61, s61, 0x700000
    v_mfma_f32_16x16x32_bf16 v[144:147], v[48:51], v[84:87], v[144:147]
    v_lshl_add_u32 v18, v1, 4, s61
    v_mfma_f32_16x16x32_bf16 v[36:39], v[20:23], v[48:51], v[36:39]
    s_waitcnt lgkmcnt(3)
    v_mfma_f32_16x16x32_bf16 v[160:163], v[48:51], v[88:91], v[160:163]
    ds_read_b128 v[104:107], v14 offset:12288
    v_mfma_f32_16x16x32_bf16 v[164:167], v[52:55], v[88:91], v[164:167]
    v_add_u32 v19, 114688, v18
    v_mfma_f32_16x16x32_bf16 v[168:171], v[56:59], v[88:91], v[168:171]
    s_mul_i32 s60, s59, 14
    v_mfma_f32_16x16x32_bf16 v[172:175], v[60:63], v[88:91], v[172:175]
    s_mul_i32 s61, s74, 224
    v_mfma_f32_16x16x32_bf16 v[36:39], v[24:27], v[52:55], v[36:39]
    s_waitcnt lgkmcnt(3)
    v_mfma_f32_16x16x32_bf16 v[188:191], v[60:63], v[92:95], v[188:191]
    ds_read_b128 v[108:111], v14 offset:14336
    v_mfma_f32_16x16x32_bf16 v[184:187], v[56:59], v[92:95], v[184:187]
    s_add_u32 s61, s61, s60
    v_mfma_f32_16x16x32_bf16 v[180:183], v[52:55], v[92:95], v[180:183]
    s_lshl_b32 s61, s61, 10
    v_mfma_f32_16x16x32_bf16 v[176:179], v[48:51], v[92:95], v[176:179]
    s_add_u32 s61, s61, 0x500000
    v_mfma_f32_16x16x32_bf16 v[36:39], v[28:31], v[56:59], v[36:39]
    s_waitcnt lgkmcnt(3)
    v_mfma_f32_16x16x32_bf16 v[192:195], v[48:51], v[96:99], v[192:195]
    v_lshl_add_u32 v16, v1, 4, s61
    v_add_u32 v17, 114688, v16
    v_mfma_f32_16x16x32_bf16 v[196:199], v[52:55], v[96:99], v[196:199]
    v_mov_b32 v44, -1
    v_mov_b32 v45, -1
    v_mfma_f32_16x16x32_bf16 v[200:203], v[56:59], v[96:99], v[200:203]
    v_mov_b32 v46, -1
    v_mov_b32 v47, -1
    v_mfma_f32_16x16x32_bf16 v[204:207], v[60:63], v[96:99], v[204:207]
    ds_write_b128 v9, v[44:47]
    v_mfma_f32_16x16x32_bf16 v[36:39], v[32:35], v[60:63], v[36:39]
    s_waitcnt lgkmcnt(3)
    v_mfma_f32_16x16x32_bf16 v[220:223], v[60:63], v[100:103], v[220:223]
    ds_read_b64_tr_b16 v[64:65], v12 offset:0
    ds_read_b64_tr_b16 v[66:67], v12 offset:512
    v_mfma_f32_16x16x32_bf16 v[216:219], v[56:59], v[100:103], v[216:219]
    ds_read_b128 v[80:83], v15 offset:0
    ds_read_b64_tr_b16 v[68:69], v13 offset:0
    v_mfma_f32_16x16x32_bf16 v[212:215], v[52:55], v[100:103], v[212:215]
    ds_read_b64_tr_b16 v[70:71], v13 offset:512
    ds_read_b64_tr_b16 v[72:73], v12 offset:8192
    v_mfma_f32_16x16x32_bf16 v[208:211], v[48:51], v[100:103], v[208:211]
    ds_read_b64_tr_b16 v[74:75], v12 offset:8704
    ds_read_b64_tr_b16 v[76:77], v13 offset:8192
    s_waitcnt lgkmcnt(10)
    v_mfma_f32_16x16x32_bf16 v[224:227], v[48:51], v[104:107], v[224:227]
    ds_read_b64_tr_b16 v[78:79], v13 offset:8704
    v_mfma_f32_16x16x32_bf16 v[228:231], v[52:55], v[104:107], v[228:231]
    ds_read_b128 v[84:87], v15 offset:2048
    v_mfma_f32_16x16x32_bf16 v[232:235], v[56:59], v[104:107], v[232:235]
    ds_read_b128 v[88:91], v15 offset:4096
    v_mfma_f32_16x16x32_bf16 v[236:239], v[60:63], v[104:107], v[236:239]
    ds_read_b128 v[92:95], v15 offset:6144
    s_waitcnt lgkmcnt(13)
    v_mfma_f32_16x16x32_bf16 v[252:255], v[60:63], v[108:111], v[252:255]
    v_mfma_f32_16x16x32_bf16 v[248:251], v[56:59], v[108:111], v[248:251]
    v_mfma_f32_16x16x32_bf16 v[244:247], v[52:55], v[108:111], v[244:247]
    v_mfma_f32_16x16x32_bf16 v[240:243], v[48:51], v[108:111], v[240:243]
    s_waitcnt lgkmcnt(9)
    v_mfma_f32_16x16x32_bf16 v[128:131], v[64:67], v[80:83], v[128:131]
    ds_read_b128 v[96:99], v15 offset:8192
    s_waitcnt lgkmcnt(8)
    v_mfma_f32_16x16x32_bf16 v[132:135], v[68:71], v[80:83], v[132:135]
    s_lshr_b32 s60, s56, 1
    s_waitcnt lgkmcnt(6)
    v_mfma_f32_16x16x32_bf16 v[136:139], v[72:75], v[80:83], v[136:139]
    s_lshl_b32 s60, s60, 9
    s_waitcnt lgkmcnt(4)
    v_mfma_f32_16x16x32_bf16 v[140:143], v[76:79], v[80:83], v[140:143]
    s_add_u32 s60, s60, 65536
    s_waitcnt lgkmcnt(3)
    v_mfma_f32_16x16x32_bf16 v[156:159], v[76:79], v[84:87], v[156:159]
    ds_read_b128 v[100:103], v15 offset:10240
    v_mfma_f32_16x16x32_bf16 v[152:155], v[72:75], v[84:87], v[152:155]
    v_and_b32 v3, 15, v1
    v_mfma_f32_16x16x32_bf16 v[148:151], v[68:71], v[84:87], v[148:151]
    v_lshl_add_u32 v3, v3, 2, s60
    v_mfma_f32_16x16x32_bf16 v[144:147], v[64:67], v[84:87], v[144:147]
    s_waitcnt lgkmcnt(3)
    v_mfma_f32_16x16x32_bf16 v[160:163], v[64:67], v[88:91], v[160:163]
    ds_read_b128 v[104:107], v15 offset:12288
    v_mfma_f32_16x16x32_bf16 v[164:167], v[68:71], v[88:91], v[164:167]
    v_mfma_f32_16x16x32_bf16 v[168:171], v[72:75], v[88:91], v[168:171]
    v_mfma_f32_16x16x32_bf16 v[172:175], v[76:79], v[88:91], v[172:175]
    s_waitcnt lgkmcnt(3)
    v_mfma_f32_16x16x32_bf16 v[188:191], v[76:79], v[92:95], v[188:191]
    ds_read_b128 v[108:111], v15 offset:14336
    v_mfma_f32_16x16x32_bf16 v[184:187], v[72:75], v[92:95], v[184:187]
    v_mfma_f32_16x16x32_bf16 v[180:183], v[68:71], v[92:95], v[180:183]
    v_mfma_f32_16x16x32_bf16 v[176:179], v[64:67], v[92:95], v[176:179]
    s_waitcnt lgkmcnt(3)
    v_mfma_f32_16x16x32_bf16 v[192:195], v[64:67], v[96:99], v[192:195]
    v_mfma_f32_16x16x32_bf16 v[196:199], v[68:71], v[96:99], v[196:199]
    v_mfma_f32_16x16x32_bf16 v[200:203], v[72:75], v[96:99], v[200:203]
    v_mfma_f32_16x16x32_bf16 v[204:207], v[76:79], v[96:99], v[204:207]
    s_waitcnt lgkmcnt(0)
    s_barrier
    s_setprio 3
    v_mfma_f32_16x16x32_bf16 v[220:223], v[76:79], v[100:103], v[220:223]
    ds_read_b64_tr_b16 v[48:49], v10 offset:16384
    ds_read_b64_tr_b16 v[50:51], v10 offset:16896
    v_mfma_f32_16x16x32_bf16 v[216:219], v[72:75], v[100:103], v[216:219]
    ds_read_b128 v[80:83], v14 offset:32768
    ds_read_b64_tr_b16 v[52:53], v11 offset:16384
    v_mfma_f32_16x16x32_bf16 v[212:215], v[68:71], v[100:103], v[212:215]
    ds_read_b64_tr_b16 v[54:55], v11 offset:16896
    ds_read_b64_tr_b16 v[56:57], v10 offset:24576
    v_mfma_f32_16x16x32_bf16 v[208:211], v[64:67], v[100:103], v[208:211]
    ds_read_b64_tr_b16 v[58:59], v10 offset:25088
    ds_read_b64_tr_b16 v[60:61], v11 offset:24576
    v_mfma_f32_16x16x32_bf16 v[224:227], v[64:67], v[104:107], v[224:227]
    ds_read_b64_tr_b16 v[62:63], v11 offset:25088
    v_mfma_f32_16x16x32_bf16 v[228:231], v[68:71], v[104:107], v[228:231]
    ds_read_b128 v[84:87], v14 offset:34816
    v_mfma_f32_16x16x32_bf16 v[232:235], v[72:75], v[104:107], v[232:235]
    ds_read_b128 v[88:91], v14 offset:36864
    v_mfma_f32_16x16x32_bf16 v[236:239], v[76:79], v[104:107], v[236:239]
    ds_read_b128 v[92:95], v15 offset:32768
    v_mfma_f32_16x16x32_bf16 v[252:255], v[76:79], v[108:111], v[252:255]
    v_mfma_f32_16x16x32_bf16 v[248:251], v[72:75], v[108:111], v[248:251]
    v_mfma_f32_16x16x32_bf16 v[244:247], v[68:71], v[108:111], v[244:247]
    v_mfma_f32_16x16x32_bf16 v[240:243], v[64:67], v[108:111], v[240:243]
    s_waitcnt lgkmcnt(10)
    v_mfma_f32_16x16x32_bf16 v[36:39], v[20:23], v[48:51], v[36:39]
    ds_read_b64_tr_b16 v[64:65], v12 offset:16384
    ds_read_b64_tr_b16 v[66:67], v12 offset:16896
    s_waitcnt lgkmcnt(9)
    v_mfma_f32_16x16x32_bf16 v[36:39], v[24:27], v[52:55], v[36:39]
    ds_read_b64_tr_b16 v[68:69], v13 offset:16384
    ds_read_b64_tr_b16 v[70:71], v13 offset:16896
    s_waitcnt lgkmcnt(9)
    v_mfma_f32_16x16x32_bf16 v[36:39], v[28:31], v[56:59], v[36:39]
    ds_read_b64_tr_b16 v[72:73], v12 offset:24576
    ds_read_b64_tr_b16 v[74:75], v12 offset:25088
    s_waitcnt lgkmcnt(9)
    v_mfma_f32_16x16x32_bf16 v[36:39], v[32:35], v[60:63], v[36:39]
    ds_read_b64_tr_b16 v[76:77], v13 offset:24576
    ds_read_b64_tr_b16 v[78:79], v13 offset:25088
    v_mfma_f32_16x16x32_bf16 v[128:131], v[48:51], v[80:83], v[128:131]
    ds_read_b128 v[96:99], v15 offset:34816
    ds_read_b128 v[100:103], v15 offset:36864
    v_mfma_f32_16x16x32_bf16 v[132:135], v[52:55], v[80:83], v[132:135]
    ds_read_b128 v[104:107], v14 offset:38912
    ds_read_b128 v[108:111], v15 offset:38912
    v_mfma_f32_16x16x32_bf16 v[136:139], v[56:59], v[80:83], v[136:139]
    ds_write_b128 v9, v[36:39]
    ds_read_b128 v[44:47], v6
    v_mfma_f32_16x16x32_bf16 v[140:143], v[60:63], v[80:83], v[140:143]
    ds_read_b32 v112, v3 offset:0
    ds_read_b32 v114, v3 offset:64
    s_waitcnt lgkmcnt(15)
    v_mfma_f32_16x16x32_bf16 v[156:159], v[60:63], v[84:87], v[156:159]
    ds_read_b32 v116, v3 offset:128
    ds_read_b32 v118, v3 offset:192
    v_mfma_f32_16x16x32_bf16 v[152:155], v[56:59], v[84:87], v[152:155]
    ds_read_b32 v120, v3 offset:256
    ds_read_b32 v122, v3 offset:320
    v_mfma_f32_16x16x32_bf16 v[148:151], v[52:55], v[84:87], v[148:151]
    ds_read_b32 v124, v3 offset:384
    ds_read_b32 v126, v3 offset:448
    v_mfma_f32_16x16x32_bf16 v[144:147], v[48:51], v[84:87], v[144:147]
    v_cmp_gt_u32 vcc, 16, v1
    v_mov_b32 v21, 0
    v_mfma_f32_16x16x32_bf16 v[160:163], v[48:51], v[88:91], v[160:163]
    v_mov_b32 v23, 0
    v_mov_b32 v25, 0
    v_mfma_f32_16x16x32_bf16 v[164:167], v[52:55], v[88:91], v[164:167]
    v_mov_b32 v27, 0
    s_waitcnt lgkmcnt(8)
    v_max3_u32 v2, v44, v45, v46
    v_max_u32 v2, v2, v47
    v_cmp_eq_u32 s[62:63], -1, v2
    s_cmp_lg_u64 s[62:63], 0
    s_cbranch_scc1 L_cs_again
L_cs_ok:
    v_mfma_f32_16x16x32_bf16 v[168:171], v[56:59], v[88:91], v[168:171]
    v_add_f32 v36, v36, v44
    v_add_f32 v37, v37, v45
    v_mfma_f32_16x16x32_bf16 v[172:175], v[60:63], v[88:91], v[172:175]
    v_add_f32 v38, v38, v46
    v_add_f32 v39, v39, v47
    v_mfma_f32_16x16x32_bf16 v[128:131], v[64:67], v[92:95], v[128:131]
    ds_read_b128 v[80:83], v14 offset:40960
    ds_read_b128 v[84:87], v15 offset:40960
    v_cvt_pk_bf16_f32 v2, -v36, -v36
    v_mfma_f32_16x16x32_bf16 v[132:135], v[68:71], v[92:95], v[132:135]
    v_and_b32 v4, 0xffff0000, v2
    v_add_f32 v4, v36, v4
    v_cvt_pk_bf16_f32 v4, -v4, -v4
    v_mfma_f32_16x16x32_bf16 v[136:139], v[72:75], v[92:95], v[136:139]
    v_alignbit_b32 v2, v4, v2, 16
    v_cndmask_b32 v20, 0, v2, vcc
    v_mfma_f32_16x16x32_bf16 v[140:143], v[76:79], v[92:95], v[140:143]
    v_cvt_pk_bf16_f32 v2, -v37, -v37
    v_and_b32 v4, 0xffff0000, v2
    v_mfma_f32_16x16x32_bf16 v[156:159], v[76:79], v[96:99], v[156:159]
    v_add_f32 v4, v37, v4
    v_cvt_pk_bf16_f32 v4, -v4, -v4
    v_mfma_f32_16x16x32_bf16 v[152:155], v[72:75], v[96:99], v[152:155]
    v_alignbit_b32 v2, v4, v2, 16
    v_cndmask_b32 v22, 0, v2, vcc
    v_mfma_f32_16x16x32_bf16 v[148:151], v[68:71], v[96:99], v[148:151]
    v_cvt_pk_bf16_f32 v2, -v38, -v38
    v_and_b32 v4, 0xffff0000, v2
    v_mfma_f32_16x16x32_bf16 v[144:147], v[64:67], v[96:99], v[144:147]
    v_add_f32 v4, v38, v4
    v_cvt_pk_bf16_f32 v4, -v4, -v4
    v_mfma_f32_16x16x32_bf16 v[160:163], v[64:67], v[100:103], v[160:163]
    v_alignbit_b32 v2, v4, v2, 16
    v_cndmask_b32 v24, 0, v2, vcc
    v_mfma_f32_16x16x32_bf16 v[164:167], v[68:71], v[100:103], v[164:167]
    v_cvt_pk_bf16_f32 v2, -v39, -v39
    v_and_b32 v4, 0xffff0000, v2
    v_mfma_f32_16x16x32_bf16 v[168:171], v[72:75], v[100:103], v[168:171]
    v_add_f32 v4, v39, v4
    v_cvt_pk_bf16_f32 v4, -v4, -v4
    v_mfma_f32_16x16x32_bf16 v[172:175], v[76:79], v[100:103], v[172:175]
    v_alignbit_b32 v2, v4, v2, 16
    v_cndmask_b32 v26, 0, v2, vcc
    s_waitcnt lgkmcnt(2)
    v_mfma_f32_16x16x16_bf16 v[128:131], v[20:21], v[112:113], v[128:131]
    ds_read_b128 v[88:91], v14 offset:43008
    v_mfma_f32_16x16x16_bf16 v[132:135], v[22:23], v[112:113], v[132:135]
    ds_read_b128 v[92:95], v15 offset:43008
    v_mfma_f32_16x16x16_bf16 v[136:139], v[24:25], v[112:113], v[136:139]
    v_mfma_f32_16x16x16_bf16 v[140:143], v[26:27], v[112:113], v[140:143]
    v_mfma_f32_16x16x16_bf16 v[144:147], v[20:21], v[114:115], v[144:147]
    s_nop 1
    v_max_f32 v128, 0, v128
    v_max_f32 v129, 0, v129
    v_mfma_f32_16x16x16_bf16 v[148:151], v[22:23], v[114:115], v[148:151]
    v_max_f32 v130, 0, v130
    v_max_f32 v131, 0, v131
    v_mfma_f32_16x16x16_bf16 v[152:155], v[24:25], v[114:115], v[152:155]
    v_max_f32 v132, 0, v132
    v_max_f32 v133, 0, v133
    v_mfma_f32_16x16x16_bf16 v[156:159], v[26:27], v[114:115], v[156:159]
    v_max_f32 v134, 0, v134
    v_max_f32 v135, 0, v135
    v_mfma_f32_16x16x32_bf16 v[188:191], v[60:63], v[104:107], v[188:191]
    v_mul_f32 v128, v128, v136
    v_mul_f32 v129, v129, v137
    v_mfma_f32_16x16x32_bf16 v[184:187], v[56:59], v[104:107], v[184:187]
    v_mul_f32 v130, v130, v138
    v_mul_f32 v131, v131, v139
    v_mfma_f32_16x16x32_bf16 v[180:183], v[52:55], v[104:107], v[180:183]
    v_mul_f32 v132, v132, v140
    v_mul_f32 v133, v133, v141
    v_mfma_f32_16x16x32_bf16 v[176:179], v[48:51], v[104:107], v[176:179]
    v_mul_f32 v134, v134, v142
    v_mul_f32 v135, v135, v143
    v_mfma_f32_16x16x32_bf16 v[188:191], v[76:79], v[108:111], v[188:191]
    v_cvt_pk_bf16_f32 v128, v128, v129
    v_cvt_pk_bf16_f32 v129, v130, v131
    v_mfma_f32_16x16x32_bf16 v[184:187], v[72:75], v[108:111], v[184:187]
    v_cvt_pk_bf16_f32 v130, v132, v133
    v_cvt_pk_bf16_f32 v131, v134, v135
    v_mfma_f32_16x16x32_bf16 v[180:183], v[68:71], v[108:111], v[180:183]
    buffer_store_dwordx4 v[128:131], v40, s[48:51], s75 offen offset:0 sc1
    v_max_f32 v144, 0, v144
    v_mfma_f32_16x16x32_bf16 v[176:179], v[64:67], v[108:111], v[176:179]
    v_max_f32 v145, 0, v145
    v_max_f32 v146, 0, v146
    v_mfma_f32_16x16x16_bf16 v[160:163], v[20:21], v[116:117], v[160:163]
    v_max_f32 v147, 0, v147
    v_max_f32 v148, 0, v148
    v_mfma_f32_16x16x16_bf16 v[164:167], v[22:23], v[116:117], v[164:167]
    v_max_f32 v149, 0, v149
    v_max_f32 v150, 0, v150
    v_mfma_f32_16x16x16_bf16 v[168:171], v[24:25], v[116:117], v[168:171]
    v_max_f32 v151, 0, v151
    v_mul_f32 v144, v144, v152
    v_mfma_f32_16x16x16_bf16 v[172:175], v[26:27], v[116:117], v[172:175]
    v_mul_f32 v145, v145, v153
    v_mul_f32 v146, v146, v154
    s_waitcnt lgkmcnt(3)
    v_mfma_f32_16x16x32_bf16 v[192:195], v[48:51], v[80:83], v[192:195]
    ds_read_b128 v[96:99], v14 offset:45056
    ds_read_b128 v[100:103], v15 offset:45056
    v_mfma_f32_16x16x32_bf16 v[196:199], v[52:55], v[80:83], v[196:199]
    ds_read_b128 v[104:107], v14 offset:47104
    ds_read_b128 v[108:111], v15 offset:47104
    v_mfma_f32_16x16x32_bf16 v[200:203], v[56:59], v[80:83], v[200:203]
    v_mul_f32 v147, v147, v155
    v_mul_f32 v148, v148, v156
    v_mfma_f32_16x16x32_bf16 v[204:207], v[60:63], v[80:83], v[204:207]
    v_mul_f32 v149, v149, v157
    v_mul_f32 v150, v150, v158
    s_waitcnt lgkmcnt(6)
    v_mfma_f32_16x16x32_bf16 v[192:195], v[64:67], v[84:87], v[192:195]
    v_mul_f32 v151, v151, v159
    v_cvt_pk_bf16_f32 v144, v144, v145
    v_mfma_f32_16x16x32_bf16 v[196:199], v[68:71], v[84:87], v[196:199]
    v_cvt_pk_bf16_f32 v145, v146, v147
    v_cvt_pk_bf16_f32 v146, v148, v149
    v_mfma_f32_16x16x32_bf16 v[200:203], v[72:75], v[84:87], v[200:203]
    v_cvt_pk_bf16_f32 v147, v150, v151
    buffer_store_dwordx4 v[144:147], v40, s[48:51], s75 offen offset:1024 sc1
    v_mfma_f32_16x16x32_bf16 v[204:207], v[76:79], v[84:87], v[204:207]
    s_add_u32 s75, s75, 114688
    v_max_f32 v160, 0, v160
    v_mfma_f32_16x16x16_bf16 v[176:179], v[20:21], v[118:119], v[176:179]
    v_max_f32 v161, 0, v161
    v_max_f32 v162, 0, v162
    v_mfma_f32_16x16x16_bf16 v[180:183], v[22:23], v[118:119], v[180:183]
    v_max_f32 v163, 0, v163
    v_max_f32 v164, 0, v164
    v_mfma_f32_16x16x16_bf16 v[184:187], v[24:25], v[118:119], v[184:187]
    v_max_f32 v165, 0, v165
    v_max_f32 v166, 0, v166
    v_mfma_f32_16x16x16_bf16 v[188:191], v[26:27], v[118:119], v[188:191]
    v_max_f32 v167, 0, v167
    v_mul_f32 v160, v160, v168
    s_waitcnt lgkmcnt(5)
    v_mfma_f32_16x16x32_bf16 v[220:223], v[60:63], v[88:91], v[220:223]
    v_mul_f32 v161, v161, v169
    v_mul_f32 v162, v162, v170
    v_mfma_f32_16x16x32_bf16 v[216:219], v[56:59], v[88:91], v[216:219]
    v_mul_f32 v163, v163, v171
    v_mul_f32 v164, v164, v172
    v_mfma_f32_16x16x32_bf16 v[212:215], v[52:55], v[88:91], v[212:215]
    v_mul_f32 v165, v165, v173
    v_mul_f32 v166, v166, v174
    v_mfma_f32_16x16x32_bf16 v[208:211], v[48:51], v[88:91], v[208:211]
    v_mul_f32 v167, v167, v175
    v_cvt_pk_bf16_f32 v160, v160, v161
    s_waitcnt lgkmcnt(4)
    v_mfma_f32_16x16x32_bf16 v[220:223], v[76:79], v[92:95], v[220:223]
    v_cvt_pk_bf16_f32 v161, v162, v163
    v_cvt_pk_bf16_f32 v162, v164, v165
    v_mfma_f32_16x16x32_bf16 v[216:219], v[72:75], v[92:95], v[216:219]
    v_cvt_pk_bf16_f32 v163, v166, v167
    buffer_store_dwordx4 v[160:163], v40, s[48:51], s75 offen offset:0 sc1
    v_mfma_f32_16x16x32_bf16 v[212:215], v[68:71], v[92:95], v[212:215]
    v_max_f32 v176, 0, v176
    v_max_f32 v177, 0, v177
    v_mfma_f32_16x16x32_bf16 v[208:211], v[64:67], v[92:95], v[208:211]
    v_max_f32 v178, 0, v178
    v_max_f32 v179, 0, v179
    v_mfma_f32_16x16x16_bf16 v[192:195], v[20:21], v[120:121], v[192:195]
    v_max_f32 v180, 0, v180
    v_max_f32 v181, 0, v181
    v_mfma_f32_16x16x16_bf16 v[196:199], v[22:23], v[120:121], v[196:199]
    v_max_f32 v182, 0, v182
    v_max_f32 v183, 0, v183
    v_mfma_f32_16x16x16_bf16 v[200:203], v[24:25], v[120:121], v[200:203]
    v_mul_f32 v176, v176, v184
    v_mul_f32 v177, v177, v185
    v_mfma_f32_16x16x16_bf16 v[204:207], v[26:27], v[120:121], v[204:207]
    v_mul_f32 v178, v178, v186
    v_mul_f32 v179, v179, v187
    s_waitcnt lgkmcnt(3)
    v_mfma_f32_16x16x32_bf16 v[224:227], v[48:51], v[96:99], v[224:227]
    s_waitcnt lgkmcnt(0)
    s_lshl_b32 s60, s56, 2
    s_add_u32 s60, s60, 157184
    v_mfma_f32_16x16x32_bf16 v[228:231], v[52:55], v[96:99], v[228:231]
    v_mov_b32 v3, s60
    v_mov_b32 v2, -1
    v_mfma_f32_16x16x32_bf16 v[232:235], v[56:59], v[96:99], v[232:235]
    ds_write_b32 v3, v2 offset:48
    v_mul_f32 v180, v180, v188
    v_mfma_f32_16x16x32_bf16 v[236:239], v[60:63], v[96:99], v[236:239]
    v_mul_f32 v181, v181, v189
    v_mul_f32 v182, v182, v190
    v_mfma_f32_16x16x32_bf16 v[224:227], v[64:67], v[100:103], v[224:227]
    v_mul_f32 v183, v183, v191
    v_cvt_pk_bf16_f32 v176, v176, v177
    v_mfma_f32_16x16x32_bf16 v[228:231], v[68:71], v[100:103], v[228:231]
    v_cvt_pk_bf16_f32 v177, v178, v179
    v_cvt_pk_bf16_f32 v178, v180, v181
    v_mfma_f32_16x16x32_bf16 v[232:235], v[72:75], v[100:103], v[232:235]
    v_cvt_pk_bf16_f32 v179, v182, v183
    buffer_store_dwordx4 v[176:179], v40, s[48:51], s75 offen offset:1024 sc1
    v_mfma_f32_16x16x32_bf16 v[236:239], v[76:79], v[100:103], v[236:239]
    s_add_u32 s75, s75, 114688
    v_max_f32 v192, 0, v192
    v_mfma_f32_16x16x16_bf16 v[208:211], v[20:21], v[122:123], v[208:211]
    v_max_f32 v193, 0, v193
    v_max_f32 v194, 0, v194
    v_mfma_f32_16x16x16_bf16 v[212:215], v[22:23], v[122:123], v[212:215]
    v_max_f32 v195, 0, v195
    v_max_f32 v196, 0, v196
    v_mfma_f32_16x16x16_bf16 v[216:219], v[24:25], v[122:123], v[216:219]
    v_max_f32 v197, 0, v197
    v_max_f32 v198, 0, v198
    v_mfma_f32_16x16x16_bf16 v[220:223], v[26:27], v[122:123], v[220:223]
    v_max_f32 v199, 0, v199
    v_mul_f32 v192, v192, v200
    v_mfma_f32_16x16x32_bf16 v[252:255], v[60:63], v[104:107], v[252:255]
    v_mul_f32 v193, v193, v201
    v_mul_f32 v194, v194, v202
    v_mfma_f32_16x16x32_bf16 v[248:251], v[56:59], v[104:107], v[248:251]
    v_mul_f32 v195, v195, v203
    v_mul_f32 v196, v196, v204
    v_mfma_f32_16x16x32_bf16 v[244:247], v[52:55], v[104:107], v[244:247]
    v_mul_f32 v197, v197, v205
    v_mul_f32 v198, v198, v206
    v_mfma_f32_16x16x32_bf16 v[240:243], v[48:51], v[104:107], v[240:243]
    v_mul_f32 v199, v199, v207
    v_cvt_pk_bf16_f32 v192, v192, v193
    v_mfma_f32_16x16x32_bf16 v[252:255], v[76:79], v[108:111], v[252:255]
    v_cvt_pk_bf16_f32 v193, v194, v195
    v_cvt_pk_bf16_f32 v194, v196, v197
    v_mfma_f32_16x16x32_bf16 v[248:251], v[72:75], v[108:111], v[248:251]
    v_cvt_pk_bf16_f32 v195, v198, v199
    buffer_store_dwordx4 v[192:195], v40, s[48:51], s75 offen offset:0 sc1
    v_mfma_f32_16x16x32_bf16 v[244:247], v[68:71], v[108:111], v[244:247]
    v_max_f32 v208, 0, v208
    v_max_f32 v209, 0, v209
    v_mfma_f32_16x16x32_bf16 v[240:243], v[64:67], v[108:111], v[240:243]
    v_max_f32 v210, 0, v210
    v_max_f32 v211, 0, v211
    v_mfma_f32_16x16x16_bf16 v[224:227], v[20:21], v[124:125], v[224:227]
    v_max_f32 v212, 0, v212
    v_max_f32 v213, 0, v213
    v_mfma_f32_16x16x16_bf16 v[228:231], v[22:23], v[124:125], v[228:231]
    v_max_f32 v214, 0, v214
    v_max_f32 v215, 0, v215
    v_mfma_f32_16x16x16_bf16 v[232:235], v[24:25], v[124:125], v[232:235]
    v_mul_f32 v208, v208, v216
    v_mul_f32 v209, v209, v217
    v_mfma_f32_16x16x16_bf16 v[236:239], v[26:27], v[124:125], v[236:239]
    v_mul_f32 v210, v210, v218
    v_mul_f32 v211, v211, v219
    v_mfma_f32_16x16x16_bf16 v[240:243], v[20:21], v[126:127], v[240:243]
    v_mul_f32 v212, v212, v220
    v_mul_f32 v213, v213, v221
    v_mfma_f32_16x16x16_bf16 v[244:247], v[22:23], v[126:127], v[244:247]
    v_mul_f32 v214, v214, v222
    v_mul_f32 v215, v215, v223
    v_mfma_f32_16x16x16_bf16 v[248:251], v[24:25], v[126:127], v[248:251]
    v_cvt_pk_bf16_f32 v208, v208, v209
    v_cvt_pk_bf16_f32 v209, v210, v211
    v_mfma_f32_16x16x16_bf16 v[252:255], v[26:27], v[126:127], v[252:255]
    v_cvt_pk_bf16_f32 v210, v212, v213
    v_cvt_pk_bf16_f32 v211, v214, v215
    buffer_store_dwordx4 v[208:211], v40, s[48:51], s75 offen offset:1024 sc1
    s_add_u32 s75, s75, 114688
    v_max_f32 v224, 0, v224
    v_max_f32 v225, 0, v225
    v_max_f32 v226, 0, v226
    v_max_f32 v227, 0, v227
    v_max_f32 v228, 0, v228
    v_max_f32 v229, 0, v229
    v_max_f32 v230, 0, v230
    v_max_f32 v231, 0, v231
    v_mul_f32 v224, v224, v232
    v_mul_f32 v225, v225, v233
    v_mul_f32 v226, v226, v234
    v_mul_f32 v227, v227, v235
    v_mul_f32 v228, v228, v236
    v_mul_f32 v229, v229, v237
    v_mul_f32 v230, v230, v238
    v_mul_f32 v231, v231, v239
    v_cvt_pk_bf16_f32 v224, v224, v225
    v_cvt_pk_bf16_f32 v225, v226, v227
    v_cvt_pk_bf16_f32 v226, v228, v229
    v_cvt_pk_bf16_f32 v227, v230, v231
    buffer_store_dwordx4 v[224:227], v40, s[48:51], s75 offen offset:0 sc1
    v_max_f32 v240, 0, v240
    v_max_f32 v241, 0, v241
    v_max_f32 v242, 0, v242
    v_max_f32 v243, 0, v243
    v_max_f32 v244, 0, v244
    v_max_f32 v245, 0, v245
    v_max_f32 v246, 0, v246
    v_max_f32 v247, 0, v247
    v_mul_f32 v240, v240, v248
    v_mul_f32 v241, v241, v249
    v_mul_f32 v242, v242, v250
    v_mul_f32 v243, v243, v251
    v_mul_f32 v244, v244, v252
    v_mul_f32 v245, v245, v253
    v_mul_f32 v246, v246, v254
    v_mul_f32 v247, v247, v255
    v_cvt_pk_bf16_f32 v240, v240, v241
    v_cvt_pk_bf16_f32 v241, v242, v243
    v_cvt_pk_bf16_f32 v242, v244, v245
    v_cvt_pk_bf16_f32 v243, v246, v247
    buffer_store_dwordx4 v[240:243], v40, s[48:51], s75 offen offset:1024 sc1
    s_add_u32 s75, s75, 114688
    s_setprio 0
L_g_tail:
    s_lshl_b32 s60, s64, 1
    s_lshr_b32 s61, s56, 1
    s_add_u32 s60, s60, s61
    s_mul_i32 s60, s60, 56
    s_lshl_b32 s61, s65, 1
    s_add_u32 s60, s60, s61
    s_and_b32 s61, s56, 1
    s_add_u32 s60, s60, s61
    s_lshl_b32 s60, s60, 7
    s_add_u32 s77, s60, 0x8000
    v_mov_b32 v6, s69
    s_lshl_b32 s60, s65, 1
    s_and_b32 s61, s56, 1
    s_add_u32 s60, s60, s61
    s_mul_i32 s60, s60, 37
    s_lshr_b32 s60, s60, 8
    s_lshl_b32 s61, s64, 4
    s_add_u32 s60, s60, s61
    s_lshr_b32 s61, s56, 1
    s_lshl_b32 s61, s61, 3
    s_add_u32 s60, s60, s61
    s_lshl_b32 s60, s60, 9
    s_add_u32 s77, s60, 0x8000
    v_mov_b32 v6, 1
    v_lshlrev_b32 v31, 7, v1
    s_lshr_b32 s60, s73, 1
    s_lshl_b32 s60, s60, 3
    s_add_u32 s60, s60, s59
    s_lshl_b32 s60, s60, 2
    s_lshr_b32 s61, s74, 1
    s_add_u32 s60, s60, s61
    s_lshl_b32 s60, s60, 7
    s_add_u32 s5, s60, 0x8000
    s_add_u32 s7, s69, 7
    s_mov_b32 s52, s34
    s_mov_b32 s53, s35
    s_mov_b32 s54, 0x200000
    s_mov_b32 s55, 0x20000
    v_bfe_u32 v2, v1, 3, 1
    v_bfe_u32 v3, v1, 2, 1
    v_xor_b32 v2, v2, v3
    v_lshrrev_b32 v3, 4, v1
    v_lshl_add_u32 v2, v3, 1, v2
    s_lshl_b32 s60, s73, 6
    s_lshl_b32 s61, s56, 3
    s_add_u32 s60, s60, s61
    v_add_u32 v3, s60, v2
    v_and_b32 v4, 7, v1
    v_lshlrev_b32 v4, 4, v4
    s_lshl_b32 s60, s74, 7
    v_add_u32 v4, s60, v4
    v_lshl_add_u32 v28, v3, 10, v4
    v_lshlrev_b32 v5, 3, v3
    s_lshl_b32 s60, s56, 3
    v_add_u32 v3, s60, v2
    v_mul_u32_u24 v3, 272, v3
    v_and_b32 v64, 7, v1
    v_lshl_add_u32 v29, v64, 5, v3
    s_lshl_b32 s60, s56, 1
    v_lshrrev_b32 v3, 2, v2
    v_add_u32 v3, s60, v3
    v_and_b32 v64, 7, v1
    v_xor_b32 v3, v3, v64
    v_lshlrev_b32 v3, 4, v3
    v_lshl_add_u32 v3, v64, 10, v3
    v_and_b32 v64, 3, v2
    v_lshl_add_u32 v3, v64, 2, v3
    v_add_u32 v30, 104448, v3
    v_mov_b32 v24, v4
    v_mov_b32 v20, v5
    s_cmp_lt_u32 s58, 28
    s_cselect_b64 s[26:27], 15, 0
    s_waitcnt vmcnt(0)
    s_mov_b64 exec, s[26:27]
    buffer_atomic_add v6, v31, s[48:51], s77 offen sc1
    s_mov_b64 exec, -1
    buffer_load_dwordx4 v[144:147], v16, s[48:51], s89 offen offset:0 sc1
    buffer_load_dwordx4 v[148:151], v17, s[48:51], s89 offen offset:0 sc1
    buffer_load_dwordx4 v[152:155], v16, s[48:51], s89 offen offset:1024 sc1
    buffer_load_dwordx4 v[156:159], v17, s[48:51], s89 offen offset:1024 sc1
    buffer_load_dwordx4 v[160:163], v16, s[48:51], s90 offen offset:0 sc1
    buffer_load_dwordx4 v[164:167], v17, s[48:51], s90 offen offset:0 sc1
    buffer_load_dwordx4 v[168:171], v16, s[48:51], s90 offen offset:1024 sc1
    buffer_load_dwordx4 v[172:175], v17, s[48:51], s90 offen offset:1024 sc1
    buffer_load_dwordx4 v[176:179], v16, s[48:51], s91 offen offset:0 sc1
    buffer_load_dwordx4 v[180:183], v17, s[48:51], s91 offen offset:0 sc1
    buffer_load_dwordx4 v[184:187], v16, s[48:51], s91 offen offset:1024 sc1
    buffer_load_dwordx4 v[188:191], v17, s[48:51], s91 offen offset:1024 sc1
    buffer_load_dwordx4 v[192:195], v16, s[48:51], s92 offen offset:0 sc1
    buffer_load_dwordx4 v[196:199], v17, s[48:51], s92 offen offset:0 sc1
    buffer_load_dwordx4 v[200:203], v16, s[48:51], s92 offen offset:1024 sc1
    buffer_load_dwordx4 v[204:207], v17, s[48:51], s92 offen offset:1024 sc1
    buffer_load_dwordx4 v[208:211], v16, s[48:51], s93 offen offset:0 sc1
    buffer_load_dwordx4 v[212:215], v17, s[48:51], s93 offen offset:0 sc1
    buffer_load_dwordx4 v[216:219], v16, s[48:51], s93 offen offset:1024 sc1
    buffer_load_dwordx4 v[220:223], v17, s[48:51], s93 offen offset:1024 sc1
    s_buffer_load_dword s6, s[48:51], s5 glc
    buffer_load_dwordx4 v[224:227], v16, s[48:51], s94 offen offset:0 sc1
    buffer_load_dwordx4 v[228:231], v17, s[48:51], s94 offen offset:0 sc1
    buffer_load_dwordx4 v[232:235], v16, s[48:51], s94 offen offset:1024 sc1
    buffer_load_dwordx4 v[236:239], v17, s[48:51], s94 offen offset:1024 sc1
    buffer_load_dwordx4 v[240:243], v16, s[48:51], s95 offen offset:0 sc1
    buffer_load_dwordx4 v[244:247], v17, s[48:51], s95 offen offset:0 sc1
    buffer_load_dwordx4 v[248:251], v16, s[48:51], s95 offen offset:1024 sc1
    buffer_load_dwordx4 v[252:255], v17, s[48:51], s95 offen offset:1024 sc1
    s_lshr_b32 s60, s73, 3
    s_lshl_b32 s60, s60, 8
    s_lshl_b32 s61, s74, 5
    s_add_u32 s60, s60, s61
    v_and_b32 v5, 31, v1
    v_add_u32 v5, s60, v5
    v_lshlrev_b32 v5, 5, v5
    v_add_u32 v5, 0x28000, v5
    v_lshrrev_b32 v3, 4, v1
    v_and_b32 v4, 15, v1
    s_lshl_b32 s60, s56, 1
    v_xor_b32 v4, s60, v4
    v_lshlrev_b32 v4, 4, v4
    v_lshl_add_u32 v3, v3, 13, v4
    v_xor_b32 v4, 16, v3
    v_add_u32 v4, 0x8000, v4
    s_lshl_b32 s60, s74, 18
    s_lshl_b32 s61, s56, 16
    s_add_u32 s60, s60, s61
    s_lshl_b32 s61, s73, 8
    s_add_u32 s60, s60, s61
    s_add_u32 s77, s60, 0x300000
    s_lshl_b32 s61, s56, 11
    s_add_u32 s61, s61, 104448
    v_lshl_add_u32 v6, v1, 4, s61
    s_mov_b32 s76, 262144
L_gh:
    s_waitcnt lgkmcnt(0)
    s_cmp_eq_u32 s6, s7
    s_cbranch_scc1 L_gh_ok
    s_buffer_load_dword s6, s[48:51], s5 glc
    s_sub_u32 s76, s76, 1
    s_cbranch_scc0 L_gh
L_gh_ok:
    buffer_load_dwordx4 v[32:35], v18, s[48:51], s89 offen offset:0 sc1
    buffer_load_dwordx4 v[36:39], v18, s[48:51], s89 offen offset:1024 sc1
    buffer_load_dwordx4 v[40:43], v18, s[48:51], s90 offen offset:0 sc1
    buffer_load_dwordx4 v[44:47], v18, s[48:51], s90 offen offset:1024 sc1
    buffer_load_dwordx4 v[48:51], v18, s[48:51], s91 offen offset:0 sc1
    buffer_load_dwordx4 v[52:55], v18, s[48:51], s91 offen offset:1024 sc1
    buffer_load_dwordx4 v[56:59], v18, s[48:51], s92 offen offset:0 sc1
    buffer_load_dwordx4 v[60:63], v18, s[48:51], s92 offen offset:1024 sc1
    s_waitcnt vmcnt(7)
    v_mfma_f32_16x16x32_bf16 v[80:83], v[144:147], v[32:35], 0
    v_mfma_f32_16x16x32_bf16 v[84:87], v[148:151], v[32:35], 0
    v_mfma_f32_16x16x32_bf16 v[88:91], v[152:155], v[32:35], 0
    v_mfma_f32_16x16x32_bf16 v[92:95], v[156:159], v[32:35], 0
    buffer_load_dwordx4 v[32:35], v18, s[48:51], s93 offen offset:0 sc1
    s_mov_b32 s60, 32768
    s_mov_b32 s61, 0x80000
    buffer_load_dwordx4 v[8:11], v28, s[40:43], 0 offen
    buffer_load_dwordx4 v[12:15], v28, s[40:43], s60 offen
    buffer_load_dwordx2 v[22:23], v20, s[48:51], s61 offen offset:256 sc1
    buffer_load_dwordx2 v[20:21], v20, s[48:51], s61 offen sc1
    global_load_dwordx4 v[24:27], v24, s[24:25]
    s_waitcnt vmcnt(12)
    v_mfma_f32_16x16x32_bf16 v[108:111], v[156:159], v[36:39], 0
    v_mfma_f32_16x16x32_bf16 v[104:107], v[152:155], v[36:39], 0
    v_mfma_f32_16x16x32_bf16 v[100:103], v[148:151], v[36:39], 0
    v_mfma_f32_16x16x32_bf16 v[96:99], v[144:147], v[36:39], 0
    buffer_load_dwordx4 v[36:39], v18, s[48:51], s93 offen offset:1024 sc1
    s_waitcnt vmcnt(12)
    v_mfma_f32_16x16x32_bf16 v[80:83], v[160:163], v[40:43], v[80:83]
    v_mfma_f32_16x16x32_bf16 v[84:87], v[164:167], v[40:43], v[84:87]
    v_mfma_f32_16x16x32_bf16 v[88:91], v[168:171], v[40:43], v[88:91]
    v_mfma_f32_16x16x32_bf16 v[92:95], v[172:175], v[40:43], v[92:95]
    buffer_load_dwordx4 v[40:43], v18, s[48:51], s94 offen offset:0 sc1
    s_waitcnt vmcnt(12)
    v_mfma_f32_16x16x32_bf16 v[108:111], v[172:175], v[44:47], v[108:111]
    v_mfma_f32_16x16x32_bf16 v[104:107], v[168:171], v[44:47], v[104:107]
    v_mfma_f32_16x16x32_bf16 v[100:103], v[164:167], v[44:47], v[100:103]
    v_mfma_f32_16x16x32_bf16 v[96:99], v[160:163], v[44:47], v[96:99]
    buffer_load_dwordx4 v[44:47], v18, s[48:51], s94 offen offset:1024 sc1
    s_waitcnt vmcnt(12)
    v_mfma_f32_16x16x32_bf16 v[80:83], v[176:179], v[48:51], v[80:83]
    v_mfma_f32_16x16x32_bf16 v[84:87], v[180:183], v[48:51], v[84:87]
    v_mfma_f32_16x16x32_bf16 v[88:91], v[184:187], v[48:51], v[88:91]
    v_mfma_f32_16x16x32_bf16 v[92:95], v[188:191], v[48:51], v[92:95]
    buffer_load_dwordx4 v[48:51], v18, s[48:51], s95 offen offset:0 sc1
    s_waitcnt vmcnt(12)
    v_mfma_f32_16x16x32_bf16 v[108:111], v[188:191], v[52:55], v[108:111]
    v_mfma_f32_16x16x32_bf16 v[104:107], v[184:187], v[52:55], v[104:107]
    v_mfma_f32_16x16x32_bf16 v[100:103], v[180:183], v[52:55], v[100:103]
    v_mfma_f32_16x16x32_bf16 v[96:99], v[176:179], v[52:55], v[96:99]
    buffer_load_dwordx4 v[52:55], v18, s[48:51], s95 offen offset:1024 sc1
    s_waitcnt vmcnt(12)
    v_mfma_f32_16x16x32_bf16 v[80:83], v[192:195], v[56:59], v[80:83]
    v_mfma_f32_16x16x32_bf16 v[84:87], v[196:199], v[56:59], v[84:87]
    v_mfma_f32_16x16x32_bf16 v[88:91], v[200:203], v[56:59], v[88:91]
    v_mfma_f32_16x16x32_bf16 v[92:95], v[204:207], v[56:59], v[92:95]
    buffer_load_dwordx4 v[56:59], v19, s[48:51], s89 offen offset:0 sc1
    s_waitcnt vmcnt(12)
    v_mfma_f32_16x16x32_bf16 v[108:111], v[204:207], v[60:63], v[108:111]
    v_mfma_f32_16x16x32_bf16 v[104:107], v[200:203], v[60:63], v[104:107]
    v_mfma_f32_16x16x32_bf16 v[100:103], v[196:199], v[60:63], v[100:103]
    v_mfma_f32_16x16x32_bf16 v[96:99], v[192:195], v[60:63], v[96:99]
    buffer_load_dwordx4 v[60:63], v19, s[48:51], s89 offen offset:1024 sc1
    s_waitcnt vmcnt(12)
    v_mfma_f32_16x16x32_bf16 v[80:83], v[208:211], v[32:35], v[80:83]
    v_mfma_f32_16x16x32_bf16 v[84:87], v[212:215], v[32:35], v[84:87]
    v_mfma_f32_16x16x32_bf16 v[88:91], v[216:219], v[32:35], v[88:91]
    v_mfma_f32_16x16x32_bf16 v[92:95], v[220:223], v[32:35], v[92:95]
    buffer_load_dwordx4 v[32:35], v19, s[48:51], s90 offen offset:0 sc1
    s_waitcnt vmcnt(8)
    v_lshlrev_b32 v112, 16, v8
    v_and_b32 v113, 0xffff0000, v8
    v_lshlrev_b32 v114, 16, v9
    v_and_b32 v115, 0xffff0000, v9
    v_lshlrev_b32 v116, 16, v10
    v_and_b32 v117, 0xffff0000, v10
    v_lshlrev_b32 v118, 16, v11
    v_and_b32 v119, 0xffff0000, v11
    v_lshlrev_b32 v64, 16, v24
    v_and_b32 v65, 0xffff0000, v24
    v_lshlrev_b32 v66, 16, v25
    v_and_b32 v67, 0xffff0000, v25
    v_lshlrev_b32 v68, 16, v26
    s_waitcnt vmcnt(7)
    v_mfma_f32_16x16x32_bf16 v[108:111], v[220:223], v[36:39], v[108:111]
    v_mfma_f32_16x16x32_bf16 v[104:107], v[216:219], v[36:39], v[104:107]
    v_mfma_f32_16x16x32_bf16 v[100:103], v[212:215], v[36:39], v[100:103]
    v_mfma_f32_16x16x32_bf16 v[96:99], v[208:211], v[36:39], v[96:99]
    buffer_load_dwordx4 v[36:39], v19, s[48:51], s90 offen offset:1024 sc1
    v_and_b32 v69, 0xffff0000, v26
    v_lshlrev_b32 v70, 16, v27
    v_and_b32 v71, 0xffff0000, v27
    v_and_b32 v20, 0xffff0000, v20
    v_mul_f32 v64, v64, v21
    v_sub_f32 v16, v112, v20
    v_fma_f32 v64, v64, v16, v112
    v_mul_f32 v65, v65, v21
    v_sub_f32 v17, v113, v20
    v_fma_f32 v65, v65, v17, v113
    v_mul_f32 v66, v66, v21
    v_sub_f32 v16, v114, v20
    v_fma_f32 v66, v66, v16, v114
    v_mul_f32 v67, v67, v21
    s_waitcnt vmcnt(7)
    v_mfma_f32_16x16x32_bf16 v[80:83], v[224:227], v[40:43], v[80:83]
    v_mfma_f32_16x16x32_bf16 v[84:87], v[228:231], v[40:43], v[84:87]
    v_mfma_f32_16x16x32_bf16 v[88:91], v[232:235], v[40:43], v[88:91]
    v_mfma_f32_16x16x32_bf16 v[92:95], v[236:239], v[40:43], v[92:95]
    buffer_load_dwordx4 v[40:43], v19, s[48:51], s91 offen offset:0 sc1
    v_sub_f32 v17, v115, v20
    v_fma_f32 v67, v67, v17, v115
    v_mul_f32 v68, v68, v21
    v_sub_f32 v16, v116, v20
    v_fma_f32 v68, v68, v16, v116
    v_mul_f32 v69, v69, v21
    v_sub_f32 v17, v117, v20
    v_fma_f32 v69, v69, v17, v117
    v_mul_f32 v70, v70, v21
    v_sub_f32 v16, v118, v20
    v_fma_f32 v70, v70, v16, v118
    v_mul_f32 v71, v71, v21
    v_sub_f32 v17, v119, v20
    v_fma_f32 v71, v71, v17, v119
    s_waitcnt vmcnt(7)
    v_mfma_f32_16x16x32_bf16 v[108:111], v[236:239], v[44:47], v[108:111]
    v_mfma_f32_16x16x32_bf16 v[104:107], v[232:235], v[44:47], v[104:107]
    v_mfma_f32_16x16x32_bf16 v[100:103], v[228:231], v[44:47], v[100:103]
    v_mfma_f32_16x16x32_bf16 v[96:99], v[224:227], v[44:47], v[96:99]
    buffer_load_dwordx4 v[44:47], v19, s[48:51], s91 offen offset:1024 sc1
    v_mul_f32 v21, v21, v21
    v_lshlrev_b32 v112, 16, v12
    v_and_b32 v113, 0xffff0000, v12
    v_lshlrev_b32 v114, 16, v13
    v_and_b32 v115, 0xffff0000, v13
    v_lshlrev_b32 v116, 16, v14
    v_and_b32 v117, 0xffff0000, v14
    v_lshlrev_b32 v118, 16, v15
    v_and_b32 v119, 0xffff0000, v15
    v_lshlrev_b32 v72, 16, v24
    v_and_b32 v73, 0xffff0000, v24
    v_lshlrev_b32 v74, 16, v25
    v_and_b32 v75, 0xffff0000, v25
    v_lshlrev_b32 v76, 16, v26
    s_waitcnt vmcnt(7)
    v_mfma_f32_16x16x32_bf16 v[80:83], v[240:243], v[48:51], v[80:83]
    v_mfma_f32_16x16x32_bf16 v[84:87], v[244:247], v[48:51], v[84:87]
    v_mfma_f32_16x16x32_bf16 v[88:91], v[248:251], v[48:51], v[88:91]
    v_mfma_f32_16x16x32_bf16 v[92:95], v[252:255], v[48:51], v[92:95]
    buffer_load_dwordx4 v[48:51], v19, s[48:51], s92 offen offset:0 sc1
    v_and_b32 v77, 0xffff0000, v26
    v_lshlrev_b32 v78, 16, v27
    v_and_b32 v79, 0xffff0000, v27
    v_and_b32 v22, 0xffff0000, v22
    v_mul_f32 v72, v72, v23
    v_sub_f32 v16, v112, v22
    v_fma_f32 v72, v72, v16, v112
    v_mul_f32 v73, v73, v23
    v_sub_f32 v17, v113, v22
    v_fma_f32 v73, v73, v17, v113
    v_mul_f32 v74, v74, v23
    v_sub_f32 v16, v114, v22
    v_fma_f32 v74, v74, v16, v114
    v_mul_f32 v75, v75, v23
    s_waitcnt vmcnt(7)
    v_mfma_f32_16x16x32_bf16 v[108:111], v[252:255], v[52:55], v[108:111]
    v_mfma_f32_16x16x32_bf16 v[104:107], v[248:251], v[52:55], v[104:107]
    v_mfma_f32_16x16x32_bf16 v[100:103], v[244:247], v[52:55], v[100:103]
    v_mfma_f32_16x16x32_bf16 v[96:99], v[240:243], v[52:55], v[96:99]
    buffer_load_dwordx4 v[52:55], v19, s[48:51], s92 offen offset:1024 sc1
    v_sub_f32 v17, v115, v22
    v_fma_f32 v75, v75, v17, v115
    v_mul_f32 v76, v76, v23
    v_sub_f32 v16, v116, v22
    v_fma_f32 v76, v76, v16, v116
    v_mul_f32 v77, v77, v23
    v_sub_f32 v17, v117, v22
    v_fma_f32 v77, v77, v17, v117
    v_mul_f32 v78, v78, v23
    v_sub_f32 v16, v118, v22
    v_fma_f32 v78, v78, v16, v118
    v_mul_f32 v79, v79, v23
    v_sub_f32 v17, v119, v22
    v_fma_f32 v79, v79, v17, v119
    v_mul_f32 v23, v23, v23
    s_waitcnt vmcnt(7)
    v_mfma_f32_16x16x32_bf16 v[112:115], v[144:147], v[56:59], 0
    v_mfma_f32_16x16x32_bf16 v[116:119], v[148:151], v[56:59], 0
    v_mfma_f32_16x16x32_bf16 v[120:123], v[152:155], v[56:59], 0
    v_mfma_f32_16x16x32_bf16 v[124:127], v[156:159], v[56:59], 0
    buffer_load_dwordx4 v[56:59], v19, s[48:51], s93 offen offset:0 sc1
    s_waitcnt vmcnt(7)
    v_mfma_f32_16x16x32_bf16 v[140:143], v[156:159], v[60:63], 0
    v_mfma_f32_16x16x32_bf16 v[136:139], v[152:155], v[60:63], 0
    v_mfma_f32_16x16x32_bf16 v[132:135], v[148:151], v[60:63], 0
    v_mfma_f32_16x16x32_bf16 v[128:131], v[144:147], v[60:63], 0
    buffer_load_dwordx4 v[60:63], v19, s[48:51], s93 offen offset:1024 sc1
    buffer_load_dwordx4 v[144:147], v19, s[48:51], s94 offen offset:0 sc1
    buffer_load_dwordx4 v[148:151], v19, s[48:51], s94 offen offset:1024 sc1
    buffer_load_dwordx4 v[152:155], v19, s[48:51], s95 offen offset:0 sc1
    buffer_load_dwordx4 v[156:159], v19, s[48:51], s95 offen offset:1024 sc1
    v_mov_b32 v2, 157184
L_gx:
    ds_read_b128 v[8:11], v2 offset:48
    s_waitcnt lgkmcnt(0)
    v_and_b32 v8, v8, v9
    v_and_b32 v8, v8, v10
    v_and_b32 v8, v8, v11
    v_cmp_eq_u32 vcc, 0, v8
    s_cbranch_vccnz L_gx
    s_mul_i32 s60, s56, 8704
    s_add_u32 s60, s60, 34816
    v_and_b32 v16, 15, v1
    v_mul_u32_u24 v16, 272, v16
    s_waitcnt vmcnt(11)
    v_mfma_f32_16x16x32_bf16 v[112:115], v[160:163], v[32:35], v[112:115]
    v_mfma_f32_16x16x32_bf16 v[116:119], v[164:167], v[32:35], v[116:119]
    v_mfma_f32_16x16x32_bf16 v[120:123], v[168:171], v[32:35], v[120:123]
    v_mfma_f32_16x16x32_bf16 v[124:127], v[172:175], v[32:35], v[124:127]
    v_and_b32 v17, 48, v1
    v_add3_u32 v16, v16, v17, s60
    ds_write_b128 v16, v[80:83] offset:0
    ds_write_b128 v16, v[84:87] offset:64
    ds_write_b128 v16, v[88:91] offset:128
    s_waitcnt vmcnt(10)
    v_mfma_f32_16x16x32_bf16 v[140:143], v[172:175], v[36:39], v[140:143]
    v_mfma_f32_16x16x32_bf16 v[136:139], v[168:171], v[36:39], v[136:139]
    v_mfma_f32_16x16x32_bf16 v[132:135], v[164:167], v[36:39], v[132:135]
    v_mfma_f32_16x16x32_bf16 v[128:131], v[160:163], v[36:39], v[128:131]
    ds_write_b128 v16, v[92:95] offset:192
    ds_write_b128 v16, v[96:99] offset:4352
    ds_write_b128 v16, v[100:103] offset:4416
    ds_write_b128 v16, v[104:107] offset:4480
    ds_write_b128 v16, v[108:111] offset:4544
    s_waitcnt vmcnt(9)
    v_mfma_f32_16x16x32_bf16 v[112:115], v[176:179], v[40:43], v[112:115]
    v_mfma_f32_16x16x32_bf16 v[116:119], v[180:183], v[40:43], v[116:119]
    v_mfma_f32_16x16x32_bf16 v[120:123], v[184:187], v[40:43], v[120:123]
    v_mfma_f32_16x16x32_bf16 v[124:127], v[188:191], v[40:43], v[124:127]
    s_waitcnt vmcnt(8)
    v_mfma_f32_16x16x32_bf16 v[140:143], v[188:191], v[44:47], v[140:143]
    v_mfma_f32_16x16x32_bf16 v[136:139], v[184:187], v[44:47], v[136:139]
    v_mfma_f32_16x16x32_bf16 v[132:135], v[180:183], v[44:47], v[132:135]
    v_mfma_f32_16x16x32_bf16 v[128:131], v[176:179], v[44:47], v[128:131]
    s_waitcnt vmcnt(7)
    v_mfma_f32_16x16x32_bf16 v[112:115], v[192:195], v[48:51], v[112:115]
    v_mfma_f32_16x16x32_bf16 v[116:119], v[196:199], v[48:51], v[116:119]
    v_mfma_f32_16x16x32_bf16 v[120:123], v[200:203], v[48:51], v[120:123]
    v_mfma_f32_16x16x32_bf16 v[124:127], v[204:207], v[48:51], v[124:127]
    s_waitcnt vmcnt(6)
    v_mfma_f32_16x16x32_bf16 v[140:143], v[204:207], v[52:55], v[140:143]
    v_mfma_f32_16x16x32_bf16 v[136:139], v[200:203], v[52:55], v[136:139]
    v_mfma_f32_16x16x32_bf16 v[132:135], v[196:199], v[52:55], v[132:135]
    v_mfma_f32_16x16x32_bf16 v[128:131], v[192:195], v[52:55], v[128:131]
    s_lshr_b32 s60, s73, 3
    s_lshl_b32 s60, s60, 3
    s_add_u32 s60, s60, s74
    s_lshl_b32 s60, s60, 3
    s_and_b32 s61, s73, 7
    s_add_u32 s60, s60, s61
    s_lshl_b32 s60, s60, 7
    s_add_u32 s5, s60, 0x28000
    s_add_u32 s7, s69, 32
    s_buffer_load_dword s6, s[48:51], s5 glc
    s_waitcnt vmcnt(5)
    v_mfma_f32_16x16x32_bf16 v[112:115], v[208:211], v[56:59], v[112:115]
    v_mfma_f32_16x16x32_bf16 v[116:119], v[212:215], v[56:59], v[116:119]
    v_mfma_f32_16x16x32_bf16 v[120:123], v[216:219], v[56:59], v[120:123]
    v_mfma_f32_16x16x32_bf16 v[124:127], v[220:223], v[56:59], v[124:127]
    s_waitcnt vmcnt(4)
    v_mfma_f32_16x16x32_bf16 v[140:143], v[220:223], v[60:63], v[140:143]
    v_mfma_f32_16x16x32_bf16 v[136:139], v[216:219], v[60:63], v[136:139]
    v_mfma_f32_16x16x32_bf16 v[132:135], v[212:215], v[60:63], v[132:135]
    v_mfma_f32_16x16x32_bf16 v[128:131], v[208:211], v[60:63], v[128:131]
    s_waitcnt lgkmcnt(0)
    s_cmp_eq_u32 s6, s7
    s_cselect_b32 s4, 1, 0
    s_cbranch_scc1 L_gy1
    buffer_load_dwordx4 v[8:11], v28, s[40:43], 0 offen
    buffer_load_dwordx4 v[12:15], v28, s[40:43], 0 offen
    s_branch L_gy2
L_gy1:
    buffer_load_dwordx4 v[8:11], v3, s[48:51], s77 offen sc1
    buffer_load_dwordx4 v[12:15], v4, s[48:51], s77 offen sc1
L_gy2:
    s_waitcnt vmcnt(5)
    v_mfma_f32_16x16x32_bf16 v[112:115], v[224:227], v[144:147], v[112:115]
    v_mfma_f32_16x16x32_bf16 v[116:119], v[228:231], v[144:147], v[116:119]
    v_mfma_f32_16x16x32_bf16 v[120:123], v[232:235], v[144:147], v[120:123]
    v_mfma_f32_16x16x32_bf16 v[124:127], v[236:239], v[144:147], v[124:127]
    s_waitcnt vmcnt(4)
    v_mfma_f32_16x16x32_bf16 v[140:143], v[236:239], v[148:151], v[140:143]
    v_mfma_f32_16x16x32_bf16 v[136:139], v[232:235], v[148:151], v[136:139]
    v_mfma_f32_16x16x32_bf16 v[132:135], v[228:231], v[148:151], v[132:135]
    v_mfma_f32_16x16x32_bf16 v[128:131], v[224:227], v[148:151], v[128:131]
    s_waitcnt vmcnt(3)
    v_mfma_f32_16x16x32_bf16 v[112:115], v[240:243], v[152:155], v[112:115]
    v_mfma_f32_16x16x32_bf16 v[116:119], v[244:247], v[152:155], v[116:119]
    v_mfma_f32_16x16x32_bf16 v[120:123], v[248:251], v[152:155], v[120:123]
    v_mfma_f32_16x16x32_bf16 v[124:127], v[252:255], v[152:155], v[124:127]
    s_waitcnt vmcnt(2)
    v_mfma_f32_16x16x32_bf16 v[140:143], v[252:255], v[156:159], v[140:143]
    v_mfma_f32_16x16x32_bf16 v[136:139], v[248:251], v[156:159], v[136:139]
    v_mfma_f32_16x16x32_bf16 v[132:135], v[244:247], v[156:159], v[132:135]
    v_mfma_f32_16x16x32_bf16 v[128:131], v[240:243], v[156:159], v[128:131]
    s_lshl_b32 s60, s56, 2
    v_add_u32 v24, s60, v2
    v_mov_b32 v25, -1
    ds_write_b128 v16, v[112:115] offset:34816
    ds_write_b128 v16, v[116:119] offset:34880
    ds_write_b128 v16, v[120:123] offset:34944
    ds_write_b128 v16, v[124:127] offset:35008
    s_nop 0
    ds_write_b128 v16, v[128:131] offset:39168
    ds_write_b128 v16, v[132:135] offset:39232
    ds_write_b128 v16, v[136:139] offset:39296
    ds_write_b128 v16, v[140:143] offset:39360
    s_cmp_lg_u32 s4, 0
    s_cbranch_scc1 L_gy3
    s_buffer_load_dword s6, s[48:51], s5 glc
    s_mov_b32 s76, 262144
L_gy:
    s_waitcnt lgkmcnt(0)
    s_cmp_eq_u32 s6, s7
    s_cbranch_scc1 L_gy_ok
    s_buffer_load_dword s6, s[48:51], s5 glc
    s_sub_u32 s76, s76, 1
    s_cbranch_scc0 L_gy
L_gy_ok:
    buffer_load_dwordx4 v[8:11], v3, s[48:51], s77 offen sc1
    buffer_load_dwordx4 v[12:15], v4, s[48:51], s77 offen sc1
L_gy3:
    v_add_u32 v3, 114688, v29
    v_add_u32 v4, 69632, v29
    s_waitcnt vmcnt(0)
    ds_write_b128 v6, v[8:11]
    ds_write_b128 v6, v[12:15] offset:1024
    s_waitcnt lgkmcnt(0)
    ds_write_b32 v24, v25 offset:32
L_gw:
    ds_read_b128 v[32:35], v2 offset:16
    ds_read_b128 v[36:39], v2 offset:32
    s_waitcnt lgkmcnt(0)
    v_and_b32 v32, v32, v33
    v_and_b32 v32, v32, v34
    v_and_b32 v32, v32, v35
    v_and_b32 v32, v32, v36
    v_and_b32 v32, v32, v37
    v_and_b32 v32, v32, v38
    v_and_b32 v32, v32, v39
    v_cmp_eq_u32 vcc, 0, v32
    s_cbranch_vccnz L_gw
    ds_read_b32 v32, v30 offset:0
    ds_read_b32 v33, v30 offset:256
    ds_read_b32 v34, v30 offset:512
    ds_read_b32 v35, v30 offset:768
    ds_read_b32 v36, v30 offset:128
    ds_read_b32 v37, v30 offset:384
    ds_read_b32 v38, v30 offset:640
    ds_read_b32 v39, v30 offset:896
    ds_read_b128 v[144:147], v29 offset:34816
    ds_read_b128 v[148:151], v29 offset:34832
    ds_read_b128 v[152:155], v29 offset:43520
    ds_read_b128 v[156:159], v29 offset:43536
    ds_read_b128 v[160:163], v29 offset:52224
    ds_read_b128 v[164:167], v29 offset:52240
    ds_read_b128 v[168:171], v29 offset:60928
    ds_read_b128 v[172:175], v29 offset:60944
    s_waitcnt lgkmcnt(12)
    v_lshlrev_b32 v40, 16, v32
    v_and_b32 v41, 0xffff0000, v32
    v_lshlrev_b32 v42, 16, v33
    v_and_b32 v43, 0xffff0000, v33
    v_lshlrev_b32 v44, 16, v34
    v_and_b32 v45, 0xffff0000, v34
    v_lshlrev_b32 v46, 16, v35
    v_and_b32 v47, 0xffff0000, v35
    ds_read_b128 v[176:179], v3 offset:0
    ds_read_b128 v[180:183], v3 offset:16
    ds_read_b128 v[184:187], v3 offset:8704
    ds_read_b128 v[188:191], v3 offset:8720
    ds_read_b128 v[192:195], v3 offset:17408
    ds_read_b128 v[196:199], v3 offset:17424
    ds_read_b128 v[200:203], v3 offset:26112
    ds_read_b128 v[204:207], v3 offset:26128
    s_waitcnt lgkmcnt(15)
    v_lshlrev_b32 v48, 16, v36
    v_and_b32 v49, 0xffff0000, v36
    v_lshlrev_b32 v50, 16, v37
    v_and_b32 v51, 0xffff0000, v37
    v_lshlrev_b32 v52, 16, v38
    v_and_b32 v53, 0xffff0000, v38
    v_lshlrev_b32 v54, 16, v39
    v_and_b32 v55, 0xffff0000, v39
    v_pk_add_f32 v[64:65], v[64:65], v[40:41]
    v_pk_add_f32 v[66:67], v[66:67], v[42:43]
    v_pk_add_f32 v[68:69], v[68:69], v[44:45]
    v_pk_add_f32 v[70:71], v[70:71], v[46:47]
    v_pk_add_f32 v[72:73], v[72:73], v[48:49]
    v_pk_add_f32 v[74:75], v[74:75], v[50:51]
    v_pk_add_f32 v[76:77], v[76:77], v[52:53]
    v_pk_add_f32 v[78:79], v[78:79], v[54:55]
    s_waitcnt lgkmcnt(8)
    ds_read_b128 v[208:211], v4 offset:0
    ds_read_b128 v[212:215], v4 offset:16
    ds_read_b128 v[216:219], v4 offset:8704
    ds_read_b128 v[220:223], v4 offset:8720
    ds_read_b128 v[224:227], v4 offset:17408
    ds_read_b128 v[228:231], v4 offset:17424
    ds_read_b128 v[232:235], v4 offset:26112
    ds_read_b128 v[236:239], v4 offset:26128
    v_pk_add_f32 v[144:145], v[144:145], v[160:161]
    v_pk_add_f32 v[146:147], v[146:147], v[162:163]
    v_pk_add_f32 v[148:149], v[148:149], v[164:165]
    v_pk_add_f32 v[150:151], v[150:151], v[166:167]
    v_pk_add_f32 v[152:153], v[152:153], v[168:169]
    v_pk_add_f32 v[154:155], v[154:155], v[170:171]
    v_pk_add_f32 v[156:157], v[156:157], v[172:173]
    v_pk_add_f32 v[158:159], v[158:159], v[174:175]
    s_waitcnt lgkmcnt(8)
    v_pk_add_f32 v[176:177], v[176:177], v[192:193]
    v_pk_add_f32 v[178:179], v[178:179], v[194:195]
    v_pk_add_f32 v[180:181], v[180:181], v[196:197]
    v_pk_add_f32 v[182:183], v[182:183], v[198:199]
    v_pk_add_f32 v[184:185], v[184:185], v[200:201]
    v_pk_add_f32 v[186:187], v[186:187], v[202:203]
    v_pk_add_f32 v[188:189], v[188:189], v[204:205]
    v_pk_add_f32 v[190:191], v[190:191], v[206:207]
    v_pk_add_f32 v[144:145], v[144:145], v[152:153]
    v_pk_add_f32 v[146:147], v[146:147], v[154:155]
    v_pk_add_f32 v[148:149], v[148:149], v[156:157]
    v_pk_add_f32 v[150:151], v[150:151], v[158:159]
    v_pk_add_f32 v[176:177], v[176:177], v[184:185]
    v_pk_add_f32 v[178:179], v[178:179], v[186:187]
    v_pk_add_f32 v[180:181], v[180:181], v[188:189]
    v_pk_add_f32 v[182:183], v[182:183], v[190:191]
    s_waitcnt lgkmcnt(0)
    v_pk_add_f32 v[208:209], v[208:209], v[224:225]
    v_pk_add_f32 v[210:211], v[210:211], v[226:227]
    v_pk_add_f32 v[212:213], v[212:213], v[228:229]
    v_pk_add_f32 v[214:215], v[214:215], v[230:231]
    v_pk_add_f32 v[144:145], v[144:145], v[176:177]
    v_pk_add_f32 v[146:147], v[146:147], v[178:179]
    v_pk_add_f32 v[148:149], v[148:149], v[180:181]
    v_pk_add_f32 v[150:151], v[150:151], v[182:183]
    v_pk_add_f32 v[216:217], v[216:217], v[232:233]
    v_pk_add_f32 v[218:219], v[218:219], v[234:235]
    v_pk_add_f32 v[220:221], v[220:221], v[236:237]
    v_pk_add_f32 v[222:223], v[222:223], v[238:239]
    v_fma_f32 v64, v144, v21, v64
    v_fma_f32 v65, v145, v21, v65
    v_fma_f32 v66, v146, v21, v66
    v_fma_f32 v67, v147, v21, v67
    v_fma_f32 v68, v148, v21, v68
    v_fma_f32 v69, v149, v21, v69
    v_fma_f32 v70, v150, v21, v70
    v_fma_f32 v71, v151, v21, v71
    v_cvt_pk_bf16_f32 v152, v64, v65
    v_cvt_pk_bf16_f32 v153, v66, v67
    v_cvt_pk_bf16_f32 v154, v68, v69
    v_cvt_pk_bf16_f32 v155, v70, v71
    buffer_store_dwordx4 v[152:155], v28, s[52:55], 0 offen
    v_pk_add_f32 v[208:209], v[208:209], v[216:217]
    v_pk_add_f32 v[210:211], v[210:211], v[218:219]
    v_pk_add_f32 v[212:213], v[212:213], v[220:221]
    v_pk_add_f32 v[214:215], v[214:215], v[222:223]
    v_fma_f32 v72, v208, v23, v72
    v_fma_f32 v73, v209, v23, v73
    v_fma_f32 v74, v210, v23, v74
    v_fma_f32 v75, v211, v23, v75
    v_fma_f32 v76, v212, v23, v76
    v_fma_f32 v77, v213, v23, v77
    v_fma_f32 v78, v214, v23, v78
    v_fma_f32 v79, v215, v23, v79
    s_mov_b32 s60, 32768
    s_barrier
    ds_read_b128 v[160:163], v29 offset:0
    ds_read_b128 v[164:167], v29 offset:16
    ds_read_b128 v[168:171], v29 offset:8704
    ds_read_b128 v[172:175], v29 offset:8720
    ds_read_b128 v[176:179], v29 offset:17408
    ds_read_b128 v[180:183], v29 offset:17424
    ds_read_b128 v[184:187], v29 offset:26112
    ds_read_b128 v[188:191], v29 offset:26128
    s_waitcnt lgkmcnt(4)
    v_pk_add_f32 v[160:161], v[160:161], v[168:169]
    v_pk_add_f32 v[162:163], v[162:163], v[170:171]
    v_pk_add_f32 v[164:165], v[164:165], v[172:173]
    v_pk_add_f32 v[166:167], v[166:167], v[174:175]
    s_waitcnt lgkmcnt(0)
    v_pk_add_f32 v[176:177], v[176:177], v[184:185]
    v_pk_add_f32 v[178:179], v[178:179], v[186:187]
    v_pk_add_f32 v[180:181], v[180:181], v[188:189]
    v_pk_add_f32 v[182:183], v[182:183], v[190:191]
    v_pk_add_f32 v[160:161], v[160:161], v[176:177]
    v_pk_add_f32 v[162:163], v[162:163], v[178:179]
    v_pk_add_f32 v[164:165], v[164:165], v[180:181]
    v_pk_add_f32 v[166:167], v[166:167], v[182:183]
    v_pk_fma_f32 v[160:161], v[160:161], v[22:23], v[72:73] op_sel:[0,1,0]
    v_pk_fma_f32 v[162:163], v[162:163], v[22:23], v[74:75] op_sel:[0,1,0]
    v_pk_fma_f32 v[164:165], v[164:165], v[22:23], v[76:77] op_sel:[0,1,0]
    v_pk_fma_f32 v[166:167], v[166:167], v[22:23], v[78:79] op_sel:[0,1,0]
    v_cvt_pk_bf16_f32 v208, v160, v161
    v_cvt_pk_bf16_f32 v209, v162, v163
    v_cvt_pk_bf16_f32 v210, v164, v165
    v_cvt_pk_bf16_f32 v211, v166, v167
    buffer_store_dwordx4 v[208:211], v28, s[52:55], s60 offen
    s_endpgm
L_cs_again:
    s_mov_b32 s76, 262144
L_cs_loop:
    ds_read_b128 v[44:47], v6
    s_sub_u32 s76, s76, 1
    s_cbranch_scc1 L_cs_out
    s_waitcnt lgkmcnt(0)
    v_max3_u32 v2, v44, v45, v46
    v_max_u32 v2, v2, v47
    v_cmp_eq_u32 s[62:63], -1, v2
    s_cmp_lg_u64 s[62:63], 0
    s_cbranch_scc1 L_cs_loop
L_cs_out:
    s_waitcnt lgkmcnt(0)
    s_nop 1
    s_branch L_cs_ok
L_spare:
    s_and_b32 s60, s57, 1
    s_lshl_b32 s60, s60, 7
    s_lshr_b32 s61, s57, 1
    s_lshl_b32 s61, s61, 5
    s_add_u32 s60, s60, s61
    s_sub_u32 s61, s58, 28
    s_lshl_b32 s61, s61, 3
    s_add_u32 s60, s60, s61
    s_add_u32 s70, s60, s59
    s_lshl_b32 s62, s70, 13
    s_add_u32 s63, s62, 4096
    v_lshlrev_b32 v8, 4, v1
    s_waitcnt lgkmcnt(0)
    s_load_dword s69, s[38:39], 0
    s_mov_b32 s40, s8
    s_mov_b32 s41, s9
    s_mov_b32 s42, 0x200000
    s_mov_b32 s43, 0x20000
    s_mov_b32 s48, s38
    s_mov_b32 s49, s39
    s_mov_b32 s50, 0x1000000
    s_mov_b32 s51, 0x20000
    buffer_load_dwordx4 v[48:51], v8, s[40:43], s62 offen offset:0
    buffer_load_dwordx4 v[52:55], v8, s[40:43], s62 offen offset:1024
    buffer_load_dwordx4 v[56:59], v8, s[40:43], s62 offen offset:2048
    buffer_load_dwordx4 v[60:63], v8, s[40:43], s62 offen offset:3072
    buffer_load_dwordx4 v[64:67], v8, s[40:43], s63 offen offset:0
    buffer_load_dwordx4 v[68:71], v8, s[40:43], s63 offen offset:1024
    buffer_load_dwordx4 v[72:75], v8, s[40:43], s63 offen offset:2048
    buffer_load_dwordx4 v[76:79], v8, s[40:43], s63 offen offset:3072
    s_lshl_b32 s71, s57, 5
    s_add_u32 s71, s71, s58
    s_lshl_b32 s60, s71, 9
    v_lshl_add_u32 v6, v0, 1, s60
    s_lshl_b32 s60, s71, 2
    s_load_dword s72, s[22:23], s60
    global_load_ushort v24, v6, s[10:11] nt
    global_load_ushort v25, v6, s[12:13] nt
    global_load_ushort v26, v6, s[14:15] nt
    global_load_ushort v27, v6, s[16:17] nt
    global_load_ushort v28, v6, s[18:19] nt
    global_load_ushort v29, v6, s[20:21] nt
    s_waitcnt lgkmcnt(0)
    s_mul_i32 s69, s69, 0x9e3779b1
    s_add_u32 s69, s69, 0x7f4a7c15
    s_lshr_b32 s60, s70, 5
    s_lshl_b32 s60, s60, 4
    s_add_u32 s60, s60, s59
    s_lshl_b32 s60, s60, 2
    s_bfe_u32 s61, s70, 0x20003
    s_add_u32 s60, s60, s61
    s_lshl_b32 s60, s60, 7
    s_add_u32 s60, s60, 0x8000
    v_lshlrev_b32 v2, 12, v1
    v_mov_b32 v3, s69
    s_mov_b64 exec, 3
    buffer_store_dword v3, v2, s[48:51], s60 offen sc1
    s_lshr_b32 s60, s70, 6
    s_lshl_b32 s60, s60, 3
    s_add_u32 s60, s60, s59
    s_lshl_b32 s60, s60, 3
    s_bfe_u32 s61, s70, 0x30003
    s_add_u32 s60, s60, s61
    s_lshl_b32 s60, s60, 7
    s_add_u32 s60, s60, 0x28000
    s_mov_b64 exec, 1
    buffer_store_dword v3, off, s[48:51], s60 sc1
    s_mov_b64 exec, -1
    v_mov_b32 v3, 157312
    v_and_b32 v2, 15, v1
    v_lshl_add_u32 v2, v2, 2, v3
    v_mov_b32 v3, 0
    ds_write_b32 v2, v3
    s_waitcnt lgkmcnt(0)
    s_barrier
    s_waitcnt vmcnt(15)
    v_lshlrev_b32 v80, 16, v48
    v_and_b32 v81, 0xffff0000, v48
    v_lshlrev_b32 v82, 16, v49
    v_and_b32 v83, 0xffff0000, v49
    v_lshlrev_b32 v84, 16, v50
    v_and_b32 v85, 0xffff0000, v50
    v_lshlrev_b32 v86, 16, v51
    v_and_b32 v87, 0xffff0000, v51
    v_pk_add_f32 v[152:153], v[80:81], v[82:83]
    v_pk_add_f32 v[154:155], v[84:85], v[86:87]
    v_pk_add_f32 v[152:153], v[152:153], v[154:155]
    s_waitcnt vmcnt(14)
    v_lshlrev_b32 v88, 16, v52
    v_and_b32 v89, 0xffff0000, v52
    v_lshlrev_b32 v90, 16, v53
    v_and_b32 v91, 0xffff0000, v53
    v_lshlrev_b32 v92, 16, v54
    v_and_b32 v93, 0xffff0000, v54
    v_lshlrev_b32 v94, 16, v55
    v_and_b32 v95, 0xffff0000, v55
    v_pk_add_f32 v[156:157], v[88:89], v[90:91]
    v_pk_add_f32 v[158:159], v[92:93], v[94:95]
    v_add_f32 v144, v152, v153
    v_pk_add_f32 v[156:157], v[156:157], v[158:159]
    s_waitcnt vmcnt(13)
    v_lshlrev_b32 v96, 16, v56
    v_and_b32 v97, 0xffff0000, v56
    v_lshlrev_b32 v98, 16, v57
    v_and_b32 v99, 0xffff0000, v57
    v_lshlrev_b32 v100, 16, v58
    v_and_b32 v101, 0xffff0000, v58
    v_lshlrev_b32 v102, 16, v59
    v_and_b32 v103, 0xffff0000, v59
    v_pk_add_f32 v[152:153], v[96:97], v[98:99]
    v_pk_add_f32 v[154:155], v[100:101], v[102:103]
    v_add_f32 v145, v156, v157
    v_pk_add_f32 v[152:153], v[152:153], v[154:155]
    s_waitcnt vmcnt(12)
    v_lshlrev_b32 v104, 16, v60
    v_and_b32 v105, 0xffff0000, v60
    v_lshlrev_b32 v106, 16, v61
    v_and_b32 v107, 0xffff0000, v61
    v_lshlrev_b32 v108, 16, v62
    v_and_b32 v109, 0xffff0000, v62
    v_lshlrev_b32 v110, 16, v63
    v_and_b32 v111, 0xffff0000, v63
    v_pk_add_f32 v[156:157], v[104:105], v[106:107]
    v_pk_add_f32 v[158:159], v[108:109], v[110:111]
    v_add_f32 v146, v152, v153
    v_pk_add_f32 v[156:157], v[156:157], v[158:159]
    s_waitcnt vmcnt(11)
    v_lshlrev_b32 v112, 16, v64
    v_and_b32 v113, 0xffff0000, v64
    v_lshlrev_b32 v114, 16, v65
    v_and_b32 v115, 0xffff0000, v65
    v_lshlrev_b32 v116, 16, v66
    v_and_b32 v117, 0xffff0000, v66
    v_lshlrev_b32 v118, 16, v67
    v_and_b32 v119, 0xffff0000, v67
    v_pk_add_f32 v[152:153], v[112:113], v[114:115]
    v_pk_add_f32 v[154:155], v[116:117], v[118:119]
    v_add_f32 v147, v156, v157
    v_pk_add_f32 v[152:153], v[152:153], v[154:155]
    s_waitcnt vmcnt(10)
    v_lshlrev_b32 v120, 16, v68
    v_and_b32 v121, 0xffff0000, v68
    v_lshlrev_b32 v122, 16, v69
    v_and_b32 v123, 0xffff0000, v69
    v_lshlrev_b32 v124, 16, v70
    v_and_b32 v125, 0xffff0000, v70
    v_lshlrev_b32 v126, 16, v71
    v_and_b32 v127, 0xffff0000, v71
    v_pk_add_f32 v[156:157], v[120:121], v[122:123]
    v_pk_add_f32 v[158:159], v[124:125], v[126:127]
    v_add_f32 v148, v152, v153
    v_pk_add_f32 v[156:157], v[156:157], v[158:159]
    s_waitcnt vmcnt(9)
    v_lshlrev_b32 v128, 16, v72
    v_and_b32 v129, 0xffff0000, v72
    v_lshlrev_b32 v130, 16, v73
    v_and_b32 v131, 0xffff0000, v73
    v_lshlrev_b32 v132, 16, v74
    v_and_b32 v133, 0xffff0000, v74
    v_lshlrev_b32 v134, 16, v75
    v_and_b32 v135, 0xffff0000, v75
    v_pk_add_f32 v[152:153], v[128:129], v[130:131]
    v_pk_add_f32 v[154:155], v[132:133], v[134:135]
    v_add_f32 v149, v156, v157
    v_pk_add_f32 v[152:153], v[152:153], v[154:155]
    s_waitcnt vmcnt(8)
    v_lshlrev_b32 v136, 16, v76
    v_and_b32 v137, 0xffff0000, v76
    v_lshlrev_b32 v138, 16, v77
    v_and_b32 v139, 0xffff0000, v77
    v_lshlrev_b32 v140, 16, v78
    v_and_b32 v141, 0xffff0000, v78
    v_lshlrev_b32 v142, 16, v79
    v_and_b32 v143, 0xffff0000, v79
    v_pk_add_f32 v[156:157], v[136:137], v[138:139]
    v_pk_add_f32 v[158:159], v[140:141], v[142:143]
    v_add_f32 v150, v152, v153
    v_pk_add_f32 v[156:157], v[156:157], v[158:159]
    v_add_f32 v151, v156, v157
    v_permlane32_swap_b32 v144, v148
    v_permlane32_swap_b32 v145, v149
    v_permlane32_swap_b32 v146, v150
    v_permlane32_swap_b32 v147, v151
    v_add_f32 v144, v144, v148
    v_add_f32 v145, v145, v149
    v_add_f32 v146, v146, v150
    v_add_f32 v147, v147, v151
    s_nop 0
    v_permlane16_swap_b32 v144, v146
    v_permlane16_swap_b32 v145, v147
    v_add_f32 v144, v144, v146
    v_add_f32 v145, v145, v147
    s_nop 0
    v_add_f32_dpp v144, v144, v144 row_ror:8 row_mask:0xf bank_mask:0xf
    s_nop 1
    v_add_f32_dpp v144, v145, v145 row_ror:8 row_mask:0xf bank_mask:0xc
    s_nop 1
    v_add_f32_dpp v144, v144, v144 row_half_mirror row_mask:0xf bank_mask:0xf
    s_nop 1
    v_add_f32_dpp v144, v144, v144 quad_perm:[2,3,0,1] row_mask:0xf bank_mask:0xf
    s_nop 1
    v_add_f32_dpp v144, v144, v144 quad_perm:[1,0,3,2] row_mask:0xf bank_mask:0xf
    v_mul_f32 v176, 0x3b000000, v144
    s_nop 0
    v_readlane_b32 s80, v176, 0
    v_readlane_b32 s81, v176, 8
    v_readlane_b32 s82, v176, 16
    v_readlane_b32 s83, v176, 24
    v_readlane_b32 s84, v176, 32
    v_readlane_b32 s85, v176, 40
    v_readlane_b32 s86, v176, 48
    v_readlane_b32 s87, v176, 56
    v_pk_add_f32 v[152:153], v[80:81], s[80:81] op_sel:[0,0] op_sel_hi:[1,0] neg_lo:[0,1] neg_hi:[0,1]
    v_pk_add_f32 v[160:161], v[88:89], s[80:81] op_sel:[0,1] op_sel_hi:[1,1] neg_lo:[0,1] neg_hi:[0,1]
    v_pk_add_f32 v[154:155], v[82:83], s[80:81] op_sel:[0,0] op_sel_hi:[1,0] neg_lo:[0,1] neg_hi:[0,1]
    v_pk_add_f32 v[162:163], v[90:91], s[80:81] op_sel:[0,1] op_sel_hi:[1,1] neg_lo:[0,1] neg_hi:[0,1]
    v_pk_add_f32 v[156:157], v[84:85], s[80:81] op_sel:[0,0] op_sel_hi:[1,0] neg_lo:[0,1] neg_hi:[0,1]
    v_pk_add_f32 v[164:165], v[92:93], s[80:81] op_sel:[0,1] op_sel_hi:[1,1] neg_lo:[0,1] neg_hi:[0,1]
    v_pk_add_f32 v[158:159], v[86:87], s[80:81] op_sel:[0,0] op_sel_hi:[1,0] neg_lo:[0,1] neg_hi:[0,1]
    v_pk_add_f32 v[166:167], v[94:95], s[80:81] op_sel:[0,1] op_sel_hi:[1,1] neg_lo:[0,1] neg_hi:[0,1]
    v_pk_mul_f32 v[168:169], v[152:153], v[152:153]
    v_pk_mul_f32 v[170:171], v[160:161], v[160:161]
    v_pk_fma_f32 v[168:169], v[154:155], v[154:155], v[168:169]
    v_pk_fma_f32 v[170:171], v[162:163], v[162:163], v[170:171]
    v_pk_fma_f32 v[168:169], v[156:157], v[156:157], v[168:169]
    v_pk_fma_f32 v[170:171], v[164:165], v[164:165], v[170:171]
    v_pk_fma_f32 v[168:169], v[158:159], v[158:159], v[168:169]
    v_pk_fma_f32 v[170:171], v[166:167], v[166:167], v[170:171]
    v_add_f32 v144, v168, v169
    v_add_f32 v145, v170, v171
    v_pk_add_f32 v[152:153], v[96:97], s[82:83] op_sel:[0,0] op_sel_hi:[1,0] neg_lo:[0,1] neg_hi:[0,1]
    v_pk_add_f32 v[160:161], v[104:105], s[82:83] op_sel:[0,1] op_sel_hi:[1,1] neg_lo:[0,1] neg_hi:[0,1]
    v_pk_add_f32 v[154:155], v[98:99], s[82:83] op_sel:[0,0] op_sel_hi:[1,0] neg_lo:[0,1] neg_hi:[0,1]
    v_pk_add_f32 v[162:163], v[106:107], s[82:83] op_sel:[0,1] op_sel_hi:[1,1] neg_lo:[0,1] neg_hi:[0,1]
    v_pk_add_f32 v[156:157], v[100:101], s[82:83] op_sel:[0,0] op_sel_hi:[1,0] neg_lo:[0,1] neg_hi:[0,1]
    v_pk_add_f32 v[164:165], v[108:109], s[82:83] op_sel:[0,1] op_sel_hi:[1,1] neg_lo:[0,1] neg_hi:[0,1]
    v_pk_add_f32 v[158:159], v[102:103], s[82:83] op_sel:[0,0] op_sel_hi:[1,0] neg_lo:[0,1] neg_hi:[0,1]
    v_pk_add_f32 v[166:167], v[110:111], s[82:83] op_sel:[0,1] op_sel_hi:[1,1] neg_lo:[0,1] neg_hi:[0,1]
    v_pk_mul_f32 v[168:169], v[152:153], v[152:153]
    v_pk_mul_f32 v[170:171], v[160:161], v[160:161]
    v_pk_fma_f32 v[168:169], v[154:155], v[154:155], v[168:169]
    v_pk_fma_f32 v[170:171], v[162:163], v[162:163], v[170:171]
    v_pk_fma_f32 v[168:169], v[156:157], v[156:157], v[168:169]
    v_pk_fma_f32 v[170:171], v[164:165], v[164:165], v[170:171]
    v_pk_fma_f32 v[168:169], v[158:159], v[158:159], v[168:169]
    v_pk_fma_f32 v[170:171], v[166:167], v[166:167], v[170:171]
    v_add_f32 v146, v168, v169
    v_add_f32 v147, v170, v171
    v_pk_add_f32 v[152:153], v[112:113], s[84:85] op_sel:[0,0] op_sel_hi:[1,0] neg_lo:[0,1] neg_hi:[0,1]
    v_pk_add_f32 v[160:161], v[120:121], s[84:85] op_sel:[0,1] op_sel_hi:[1,1] neg_lo:[0,1] neg_hi:[0,1]
    v_pk_add_f32 v[154:155], v[114:115], s[84:85] op_sel:[0,0] op_sel_hi:[1,0] neg_lo:[0,1] neg_hi:[0,1]
    v_pk_add_f32 v[162:163], v[122:123], s[84:85] op_sel:[0,1] op_sel_hi:[1,1] neg_lo:[0,1] neg_hi:[0,1]
    v_pk_add_f32 v[156:157], v[116:117], s[84:85] op_sel:[0,0] op_sel_hi:[1,0] neg_lo:[0,1] neg_hi:[0,1]
    v_pk_add_f32 v[164:165], v[124:125], s[84:85] op_sel:[0,1] op_sel_hi:[1,1] neg_lo:[0,1] neg_hi:[0,1]
    v_pk_add_f32 v[158:159], v[118:119], s[84:85] op_sel:[0,0] op_sel_hi:[1,0] neg_lo:[0,1] neg_hi:[0,1]
    v_pk_add_f32 v[166:167], v[126:127], s[84:85] op_sel:[0,1] op_sel_hi:[1,1] neg_lo:[0,1] neg_hi:[0,1]
    v_pk_mul_f32 v[168:169], v[152:153], v[152:153]
    v_pk_mul_f32 v[170:171], v[160:161], v[160:161]
    v_pk_fma_f32 v[168:169], v[154:155], v[154:155], v[168:169]
    v_pk_fma_f32 v[170:171], v[162:163], v[162:163], v[170:171]
    v_pk_fma_f32 v[168:169], v[156:157], v[156:157], v[168:169]
    v_pk_fma_f32 v[170:171], v[164:165], v[164:165], v[170:171]
    v_pk_fma_f32 v[168:169], v[158:159], v[158:159], v[168:169]
    v_pk_fma_f32 v[170:171], v[166:167], v[166:167], v[170:171]
    v_add_f32 v148, v168, v169
    v_add_f32 v149, v170, v171
    v_pk_add_f32 v[152:153], v[128:129], s[86:87] op_sel:[0,0] op_sel_hi:[1,0] neg_lo:[0,1] neg_hi:[0,1]
    v_pk_add_f32 v[160:161], v[136:137], s[86:87] op_sel:[0,1] op_sel_hi:[1,1] neg_lo:[0,1] neg_hi:[0,1]
    v_pk_add_f32 v[154:155], v[130:131], s[86:87] op_sel:[0,0] op_sel_hi:[1,0] neg_lo:[0,1] neg_hi:[0,1]
    v_pk_add_f32 v[162:163], v[138:139], s[86:87] op_sel:[0,1] op_sel_hi:[1,1] neg_lo:[0,1] neg_hi:[0,1]
    v_pk_add_f32 v[156:157], v[132:133], s[86:87] op_sel:[0,0] op_sel_hi:[1,0] neg_lo:[0,1] neg_hi:[0,1]
    v_pk_add_f32 v[164:165], v[140:141], s[86:87] op_sel:[0,1] op_sel_hi:[1,1] neg_lo:[0,1] neg_hi:[0,1]
    v_pk_add_f32 v[158:159], v[134:135], s[86:87] op_sel:[0,0] op_sel_hi:[1,0] neg_lo:[0,1] neg_hi:[0,1]
    v_pk_add_f32 v[166:167], v[142:143], s[86:87] op_sel:[0,1] op_sel_hi:[1,1] neg_lo:[0,1] neg_hi:[0,1]
    v_pk_mul_f32 v[168:169], v[152:153], v[152:153]
    v_pk_mul_f32 v[170:171], v[160:161], v[160:161]
    v_pk_fma_f32 v[168:169], v[154:155], v[154:155], v[168:169]
    v_pk_fma_f32 v[170:171], v[162:163], v[162:163], v[170:171]
    v_pk_fma_f32 v[168:169], v[156:157], v[156:157], v[168:169]
    v_pk_fma_f32 v[170:171], v[164:165], v[164:165], v[170:171]
    v_pk_fma_f32 v[168:169], v[158:159], v[158:159], v[168:169]
    v_pk_fma_f32 v[170:171], v[166:167], v[166:167], v[170:171]
    v_add_f32 v150, v168, v169
    v_add_f32 v151, v170, v171
    v_permlane32_swap_b32 v144, v148
    v_permlane32_swap_b32 v145, v149
    v_permlane32_swap_b32 v146, v150
    v_permlane32_swap_b32 v147, v151
    v_add_f32 v144, v144, v148
    v_add_f32 v145, v145, v149
    v_add_f32 v146, v146, v150
    v_add_f32 v147, v147, v151
    s_nop 0
    v_permlane16_swap_b32 v144, v146
    v_permlane16_swap_b32 v145, v147
    v_add_f32 v144, v144, v146
    v_add_f32 v145, v145, v147
    s_nop 0
    v_add_f32_dpp v144, v144, v144 row_ror:8 row_mask:0xf bank_mask:0xf
    s_nop 1
    v_add_f32_dpp v144, v145, v145 row_ror:8 row_mask:0xf bank_mask:0xc
    s_nop 1
    v_add_f32_dpp v144, v144, v144 row_half_mirror row_mask:0xf bank_mask:0xf
    s_nop 1
    v_add_f32_dpp v144, v144, v144 quad_perm:[2,3,0,1] row_mask:0xf bank_mask:0xf
    s_nop 1
    v_add_f32_dpp v144, v144, v144 quad_perm:[1,0,3,2] row_mask:0xf bank_mask:0xf
    v_mul_f32 v144, 0x3b000000, v144
    v_cvt_pk_bf16_f32 v152, v176, v176
    v_cvt_pk_bf16_f32 v144, 0, v144
    v_and_b32 v176, 0xffff0000, v152
    v_add_f32 v144, 0x3727c5ac, v144
    v_cvt_pk_bf16_f32 v144, 0, v144
    v_sqrt_f32 v144, v144
    v_lshrrev_b32 v2, 3, v1
    v_cvt_pk_bf16_f32 v144, 0, v144
    v_lshlrev_b32 v2, 3, v2
    v_rcp_f32 v153, v144
    s_lshl_b32 s60, s70, 6
    s_add_u32 s60, s60, 0x80000
    s_mov_b32 s62, 0x01010101
    s_mov_b32 s63, s62
    v_readlane_b32 s80, v176, 0
    v_readlane_b32 s81, v176, 8
    v_readlane_b32 s82, v176, 16
    v_readlane_b32 s83, v176, 24
    v_readlane_b32 s84, v176, 32
    v_readlane_b32 s85, v176, 40
    v_readlane_b32 s86, v176, 48
    v_readlane_b32 s87, v176, 56
    v_readlane_b32 s88, v153, 0
    v_readlane_b32 s89, v153, 8
    v_readlane_b32 s90, v153, 16
    v_readlane_b32 s91, v153, 24
    v_readlane_b32 s92, v153, 32
    v_readlane_b32 s93, v153, 40
    v_readlane_b32 s94, v153, 48
    v_readlane_b32 s95, v153, 56
    s_mov_b64 exec, s[62:63]
    buffer_store_dwordx2 v[152:153], v2, s[48:51], s60 offen sc1
    s_mov_b64 exec, -1
    s_lshl_b32 s60, s70, 13
    s_add_u32 s60, s60, 0x100000
    s_add_u32 s61, s60, 4096
    v_and_b32 v9, 7, v1
    v_xor_b32 v9, s59, v9
    v_lshlrev_b32 v9, 4, v9
    v_lshl_add_u32 v9, v1, 10, v9
    v_pk_add_f32 v[80:81], v[80:81], s[80:81] op_sel:[0,0] op_sel_hi:[1,0] neg_lo:[0,1] neg_hi:[0,1]
    v_pk_add_f32 v[88:89], v[88:89], s[80:81] op_sel:[0,1] op_sel_hi:[1,1] neg_lo:[0,1] neg_hi:[0,1]
    v_pk_add_f32 v[96:97], v[96:97], s[82:83] op_sel:[0,0] op_sel_hi:[1,0] neg_lo:[0,1] neg_hi:[0,1]
    v_pk_add_f32 v[104:105], v[104:105], s[82:83] op_sel:[0,1] op_sel_hi:[1,1] neg_lo:[0,1] neg_hi:[0,1]
    v_pk_add_f32 v[112:113], v[112:113], s[84:85] op_sel:[0,0] op_sel_hi:[1,0] neg_lo:[0,1] neg_hi:[0,1]
    v_pk_add_f32 v[120:121], v[120:121], s[84:85] op_sel:[0,1] op_sel_hi:[1,1] neg_lo:[0,1] neg_hi:[0,1]
    v_pk_add_f32 v[128:129], v[128:129], s[86:87] op_sel:[0,0] op_sel_hi:[1,0] neg_lo:[0,1] neg_hi:[0,1]
    v_pk_add_f32 v[136:137], v[136:137], s[86:87] op_sel:[0,1] op_sel_hi:[1,1] neg_lo:[0,1] neg_hi:[0,1]
    v_cvt_pk_bf16_f32 v80, 0, v80
    v_cvt_pk_bf16_f32 v81, 0, v81
    v_cvt_pk_bf16_f32 v88, 0, v88
    v_cvt_pk_bf16_f32 v89, 0, v89
    v_cvt_pk_bf16_f32 v96, 0, v96
    v_cvt_pk_bf16_f32 v97, 0, v97
    v_cvt_pk_bf16_f32 v104, 0, v104
    v_cvt_pk_bf16_f32 v105, 0, v105
    v_cvt_pk_bf16_f32 v112, 0, v112
    v_cvt_pk_bf16_f32 v113, 0, v113
    v_cvt_pk_bf16_f32 v120, 0, v120
    v_cvt_pk_bf16_f32 v121, 0, v121
    v_cvt_pk_bf16_f32 v128, 0, v128
    v_cvt_pk_bf16_f32 v129, 0, v129
    v_cvt_pk_bf16_f32 v136, 0, v136
    v_cvt_pk_bf16_f32 v137, 0, v137
    v_pk_mul_f32 v[80:81], v[80:81], s[88:89] op_sel:[0,0] op_sel_hi:[1,0]
    v_pk_mul_f32 v[88:89], v[88:89], s[88:89] op_sel:[0,1] op_sel_hi:[1,1]
    v_pk_mul_f32 v[96:97], v[96:97], s[90:91] op_sel:[0,0] op_sel_hi:[1,0]
    v_pk_mul_f32 v[104:105], v[104:105], s[90:91] op_sel:[0,1] op_sel_hi:[1,1]
    v_pk_mul_f32 v[112:113], v[112:113], s[92:93] op_sel:[0,0] op_sel_hi:[1,0]
    v_pk_mul_f32 v[120:121], v[120:121], s[92:93] op_sel:[0,1] op_sel_hi:[1,1]
    v_pk_mul_f32 v[128:129], v[128:129], s[94:95] op_sel:[0,0] op_sel_hi:[1,0]
    v_pk_mul_f32 v[136:137], v[136:137], s[94:95] op_sel:[0,1] op_sel_hi:[1,1]
    v_cvt_pk_bf16_f32 v48, v136, v128
    v_cvt_pk_bf16_f32 v49, v120, v112
    v_cvt_pk_bf16_f32 v50, v104, v96
    v_cvt_pk_bf16_f32 v51, v88, v80
    ds_write_b128 v9, v[48:51] offset:0
    v_cvt_pk_bf16_f32 v52, v137, v129
    v_cvt_pk_bf16_f32 v53, v121, v113
    v_cvt_pk_bf16_f32 v54, v105, v97
    v_cvt_pk_bf16_f32 v55, v89, v81
    ds_write_b128 v9, v[52:55] offset:128
    v_pk_add_f32 v[82:83], v[82:83], s[80:81] op_sel:[0,0] op_sel_hi:[1,0] neg_lo:[0,1] neg_hi:[0,1]
    v_pk_add_f32 v[90:91], v[90:91], s[80:81] op_sel:[0,1] op_sel_hi:[1,1] neg_lo:[0,1] neg_hi:[0,1]
    v_pk_add_f32 v[98:99], v[98:99], s[82:83] op_sel:[0,0] op_sel_hi:[1,0] neg_lo:[0,1] neg_hi:[0,1]
    v_pk_add_f32 v[106:107], v[106:107], s[82:83] op_sel:[0,1] op_sel_hi:[1,1] neg_lo:[0,1] neg_hi:[0,1]
    v_pk_add_f32 v[114:115], v[114:115], s[84:85] op_sel:[0,0] op_sel_hi:[1,0] neg_lo:[0,1] neg_hi:[0,1]
    v_pk_add_f32 v[122:123], v[122:123], s[84:85] op_sel:[0,1] op_sel_hi:[1,1] neg_lo:[0,1] neg_hi:[0,1]
    v_pk_add_f32 v[130:131], v[130:131], s[86:87] op_sel:[0,0] op_sel_hi:[1,0] neg_lo:[0,1] neg_hi:[0,1]
    v_pk_add_f32 v[138:139], v[138:139], s[86:87] op_sel:[0,1] op_sel_hi:[1,1] neg_lo:[0,1] neg_hi:[0,1]
    v_cvt_pk_bf16_f32 v82, 0, v82
    v_cvt_pk_bf16_f32 v83, 0, v83
    v_cvt_pk_bf16_f32 v90, 0, v90
    v_cvt_pk_bf16_f32 v91, 0, v91
    v_cvt_pk_bf16_f32 v98, 0, v98
    v_cvt_pk_bf16_f32 v99, 0, v99
    v_cvt_pk_bf16_f32 v106, 0, v106
    v_cvt_pk_bf16_f32 v107, 0, v107
    v_cvt_pk_bf16_f32 v114, 0, v114
    v_cvt_pk_bf16_f32 v115, 0, v115
    v_cvt_pk_bf16_f32 v122, 0, v122
    v_cvt_pk_bf16_f32 v123, 0, v123
    v_cvt_pk_bf16_f32 v130, 0, v130
    v_cvt_pk_bf16_f32 v131, 0, v131
    v_cvt_pk_bf16_f32 v138, 0, v138
    v_cvt_pk_bf16_f32 v139, 0, v139
    v_pk_mul_f32 v[82:83], v[82:83], s[88:89] op_sel:[0,0] op_sel_hi:[1,0]
    v_pk_mul_f32 v[90:91], v[90:91], s[88:89] op_sel:[0,1] op_sel_hi:[1,1]
    v_pk_mul_f32 v[98:99], v[98:99], s[90:91] op_sel:[0,0] op_sel_hi:[1,0]
    v_pk_mul_f32 v[106:107], v[106:107], s[90:91] op_sel:[0,1] op_sel_hi:[1,1]
    v_pk_mul_f32 v[114:115], v[114:115], s[92:93] op_sel:[0,0] op_sel_hi:[1,0]
    v_pk_mul_f32 v[122:123], v[122:123], s[92:93] op_sel:[0,1] op_sel_hi:[1,1]
    v_pk_mul_f32 v[130:131], v[130:131], s[94:95] op_sel:[0,0] op_sel_hi:[1,0]
    v_pk_mul_f32 v[138:139], v[138:139], s[94:95] op_sel:[0,1] op_sel_hi:[1,1]
    v_cvt_pk_bf16_f32 v56, v138, v130
    v_cvt_pk_bf16_f32 v57, v122, v114
    v_cvt_pk_bf16_f32 v58, v106, v98
    v_cvt_pk_bf16_f32 v59, v90, v82
    ds_write_b128 v9, v[56:59] offset:256
    v_cvt_pk_bf16_f32 v60, v139, v131
    v_cvt_pk_bf16_f32 v61, v123, v115
    v_cvt_pk_bf16_f32 v62, v107, v99
    v_cvt_pk_bf16_f32 v63, v91, v83
    ds_write_b128 v9, v[60:63] offset:384
    v_pk_add_f32 v[84:85], v[84:85], s[80:81] op_sel:[0,0] op_sel_hi:[1,0] neg_lo:[0,1] neg_hi:[0,1]
    v_pk_add_f32 v[92:93], v[92:93], s[80:81] op_sel:[0,1] op_sel_hi:[1,1] neg_lo:[0,1] neg_hi:[0,1]
    v_pk_add_f32 v[100:101], v[100:101], s[82:83] op_sel:[0,0] op_sel_hi:[1,0] neg_lo:[0,1] neg_hi:[0,1]
    v_pk_add_f32 v[108:109], v[108:109], s[82:83] op_sel:[0,1] op_sel_hi:[1,1] neg_lo:[0,1] neg_hi:[0,1]
    v_pk_add_f32 v[116:117], v[116:117], s[84:85] op_sel:[0,0] op_sel_hi:[1,0] neg_lo:[0,1] neg_hi:[0,1]
    v_pk_add_f32 v[124:125], v[124:125], s[84:85] op_sel:[0,1] op_sel_hi:[1,1] neg_lo:[0,1] neg_hi:[0,1]
    v_pk_add_f32 v[132:133], v[132:133], s[86:87] op_sel:[0,0] op_sel_hi:[1,0] neg_lo:[0,1] neg_hi:[0,1]
    v_pk_add_f32 v[140:141], v[140:141], s[86:87] op_sel:[0,1] op_sel_hi:[1,1] neg_lo:[0,1] neg_hi:[0,1]
    v_cvt_pk_bf16_f32 v84, 0, v84
    v_cvt_pk_bf16_f32 v85, 0, v85
    v_cvt_pk_bf16_f32 v92, 0, v92
    v_cvt_pk_bf16_f32 v93, 0, v93
    v_cvt_pk_bf16_f32 v100, 0, v100
    v_cvt_pk_bf16_f32 v101, 0, v101
    v_cvt_pk_bf16_f32 v108, 0, v108
    v_cvt_pk_bf16_f32 v109, 0, v109
    v_cvt_pk_bf16_f32 v116, 0, v116
    v_cvt_pk_bf16_f32 v117, 0, v117
    v_cvt_pk_bf16_f32 v124, 0, v124
    v_cvt_pk_bf16_f32 v125, 0, v125
    v_cvt_pk_bf16_f32 v132, 0, v132
    v_cvt_pk_bf16_f32 v133, 0, v133
    v_cvt_pk_bf16_f32 v140, 0, v140
    v_cvt_pk_bf16_f32 v141, 0, v141
    v_pk_mul_f32 v[84:85], v[84:85], s[88:89] op_sel:[0,0] op_sel_hi:[1,0]
    v_pk_mul_f32 v[92:93], v[92:93], s[88:89] op_sel:[0,1] op_sel_hi:[1,1]
    v_pk_mul_f32 v[100:101], v[100:101], s[90:91] op_sel:[0,0] op_sel_hi:[1,0]
    v_pk_mul_f32 v[108:109], v[108:109], s[90:91] op_sel:[0,1] op_sel_hi:[1,1]
    v_pk_mul_f32 v[116:117], v[116:117], s[92:93] op_sel:[0,0] op_sel_hi:[1,0]
    v_pk_mul_f32 v[124:125], v[124:125], s[92:93] op_sel:[0,1] op_sel_hi:[1,1]
    v_pk_mul_f32 v[132:133], v[132:133], s[94:95] op_sel:[0,0] op_sel_hi:[1,0]
    v_pk_mul_f32 v[140:141], v[140:141], s[94:95] op_sel:[0,1] op_sel_hi:[1,1]
    v_cvt_pk_bf16_f32 v64, v140, v132
    v_cvt_pk_bf16_f32 v65, v124, v116
    v_cvt_pk_bf16_f32 v66, v108, v100
    v_cvt_pk_bf16_f32 v67, v92, v84
    ds_write_b128 v9, v[64:67] offset:512
    v_cvt_pk_bf16_f32 v68, v141, v133
    v_cvt_pk_bf16_f32 v69, v125, v117
    v_cvt_pk_bf16_f32 v70, v109, v101
    v_cvt_pk_bf16_f32 v71, v93, v85
    ds_write_b128 v9, v[68:71] offset:640
    v_pk_add_f32 v[86:87], v[86:87], s[80:81] op_sel:[0,0] op_sel_hi:[1,0] neg_lo:[0,1] neg_hi:[0,1]
    v_pk_add_f32 v[94:95], v[94:95], s[80:81] op_sel:[0,1] op_sel_hi:[1,1] neg_lo:[0,1] neg_hi:[0,1]
    v_pk_add_f32 v[102:103], v[102:103], s[82:83] op_sel:[0,0] op_sel_hi:[1,0] neg_lo:[0,1] neg_hi:[0,1]
    v_pk_add_f32 v[110:111], v[110:111], s[82:83] op_sel:[0,1] op_sel_hi:[1,1] neg_lo:[0,1] neg_hi:[0,1]
    v_pk_add_f32 v[118:119], v[118:119], s[84:85] op_sel:[0,0] op_sel_hi:[1,0] neg_lo:[0,1] neg_hi:[0,1]
    v_pk_add_f32 v[126:127], v[126:127], s[84:85] op_sel:[0,1] op_sel_hi:[1,1] neg_lo:[0,1] neg_hi:[0,1]
    v_pk_add_f32 v[134:135], v[134:135], s[86:87] op_sel:[0,0] op_sel_hi:[1,0] neg_lo:[0,1] neg_hi:[0,1]
    v_pk_add_f32 v[142:143], v[142:143], s[86:87] op_sel:[0,1] op_sel_hi:[1,1] neg_lo:[0,1] neg_hi:[0,1]
    v_cvt_pk_bf16_f32 v86, 0, v86
    v_cvt_pk_bf16_f32 v87, 0, v87
    v_cvt_pk_bf16_f32 v94, 0, v94
    v_cvt_pk_bf16_f32 v95, 0, v95
    v_cvt_pk_bf16_f32 v102, 0, v102
    v_cvt_pk_bf16_f32 v103, 0, v103
    v_cvt_pk_bf16_f32 v110, 0, v110
    v_cvt_pk_bf16_f32 v111, 0, v111
    v_cvt_pk_bf16_f32 v118, 0, v118
    v_cvt_pk_bf16_f32 v119, 0, v119
    v_cvt_pk_bf16_f32 v126, 0, v126
    v_cvt_pk_bf16_f32 v127, 0, v127
    v_cvt_pk_bf16_f32 v134, 0, v134
    v_cvt_pk_bf16_f32 v135, 0, v135
    v_cvt_pk_bf16_f32 v142, 0, v142
    v_cvt_pk_bf16_f32 v143, 0, v143
    v_pk_mul_f32 v[86:87], v[86:87], s[88:89] op_sel:[0,0] op_sel_hi:[1,0]
    v_pk_mul_f32 v[94:95], v[94:95], s[88:89] op_sel:[0,1] op_sel_hi:[1,1]
    v_pk_mul_f32 v[102:103], v[102:103], s[90:91] op_sel:[0,0] op_sel_hi:[1,0]
    v_pk_mul_f32 v[110:111], v[110:111], s[90:91] op_sel:[0,1] op_sel_hi:[1,1]
    v_pk_mul_f32 v[118:119], v[118:119], s[92:93] op_sel:[0,0] op_sel_hi:[1,0]
    v_pk_mul_f32 v[126:127], v[126:127], s[92:93] op_sel:[0,1] op_sel_hi:[1,1]
    v_pk_mul_f32 v[134:135], v[134:135], s[94:95] op_sel:[0,0] op_sel_hi:[1,0]
    v_pk_mul_f32 v[142:143], v[142:143], s[94:95] op_sel:[0,1] op_sel_hi:[1,1]
    v_cvt_pk_bf16_f32 v72, v142, v134
    v_cvt_pk_bf16_f32 v73, v126, v118
    v_cvt_pk_bf16_f32 v74, v110, v102
    v_cvt_pk_bf16_f32 v75, v94, v86
    ds_write_b128 v9, v[72:75] offset:768
    v_cvt_pk_bf16_f32 v76, v143, v135
    v_cvt_pk_bf16_f32 v77, v127, v119
    v_cvt_pk_bf16_f32 v78, v111, v103
    v_cvt_pk_bf16_f32 v79, v95, v87
    ds_write_b128 v9, v[76:79] offset:896
    s_lshl_b32 s62, s59, 13
    v_add_u32 v10, s62, v8
    v_xor_b32 v11, 16, v10
    v_xor_b32 v12, 32, v10
    v_xor_b32 v13, 48, v10
    v_xor_b32 v14, 64, v10
    v_xor_b32 v15, 80, v10
    v_xor_b32 v16, 96, v10
    v_xor_b32 v17, 112, v10
    s_waitcnt lgkmcnt(0)
    s_barrier
    ds_read_b128 v[48:51], v10 offset:0
    ds_read_b128 v[52:55], v11 offset:1024
    ds_read_b128 v[56:59], v12 offset:2048
    ds_read_b128 v[60:63], v13 offset:3072
    ds_read_b128 v[64:67], v14 offset:4096
    ds_read_b128 v[68:71], v15 offset:5120
    ds_read_b128 v[72:75], v16 offset:6144
    ds_read_b128 v[76:79], v17 offset:7168
    s_waitcnt lgkmcnt(7)
    buffer_store_dwordx4 v[48:51], v8, s[48:51], s60 offen offset:0 sc1
    s_waitcnt lgkmcnt(6)
    buffer_store_dwordx4 v[52:55], v8, s[48:51], s60 offen offset:1024 sc1
    s_waitcnt lgkmcnt(5)
    buffer_store_dwordx4 v[56:59], v8, s[48:51], s60 offen offset:2048 sc1
    s_waitcnt lgkmcnt(4)
    buffer_store_dwordx4 v[60:63], v8, s[48:51], s60 offen offset:3072 sc1
    s_waitcnt lgkmcnt(3)
    buffer_store_dwordx4 v[64:67], v8, s[48:51], s61 offen offset:0 sc1
    s_waitcnt lgkmcnt(2)
    buffer_store_dwordx4 v[68:71], v8, s[48:51], s61 offen offset:1024 sc1
    s_waitcnt lgkmcnt(1)
    buffer_store_dwordx4 v[72:75], v8, s[48:51], s61 offen offset:2048 sc1
    s_waitcnt lgkmcnt(0)
    buffer_store_dwordx4 v[76:79], v8, s[48:51], s61 offen offset:3072 sc1
    s_lshl_b32 s60, s70, 4
    s_add_u32 s77, s60, 0x1000
    v_mov_b32 v3, s69
    v_mov_b32 v55, 157312
    s_lshl_b32 s60, s56, 2
    v_add_u32 v54, s60, v55
    s_cmp_ge_u32 s59, 4
    s_cbranch_scc1 L_spare_H
    s_and_b32 s60, s57, 1
    s_lshl_b32 s60, s60, 2
    s_and_b32 s61, s58, 3
    s_add_u32 s64, s60, s61
    s_lshr_b32 s60, s57, 1
    s_mul_i32 s60, s60, 7
    s_lshr_b32 s61, s58, 2
    s_add_u32 s65, s60, s61
    s_and_b32 s60, s57, 1
    s_lshl_b32 s60, s60, 4
    s_and_b32 s61, s57, 2
    s_lshl_b32 s61, s61, 2
    s_add_u32 s60, s60, s61
    s_lshr_b32 s78, s58, 2
    s_add_u32 s73, s60, s78
    s_and_b32 s60, s57, 4
    s_and_b32 s61, s58, 3
    s_add_u32 s74, s60, s61
    s_mov_b32 s89, 0
    s_mov_b32 s90, 2048
    s_mov_b32 s91, 4096
    s_mov_b32 s92, 6144
    s_mov_b32 s93, 8192
    s_mov_b32 s94, 10240
    s_mov_b32 s95, 12288
    s_mul_i32 s60, s59, 14
    s_mul_i32 s61, s73, 224
    s_add_u32 s61, s61, s60
    s_lshl_b32 s61, s61, 10
    s_add_u32 s61, s61, 0x700000
    v_lshl_add_u32 v18, v1, 4, s61
    v_add_u32 v19, 114688, v18
    s_mul_i32 s60, s59, 14
    s_mul_i32 s61, s74, 224
    s_add_u32 s61, s61, s60
    s_lshl_b32 s61, s61, 10
    s_add_u32 s61, s61, 0x500000
    v_lshl_add_u32 v16, v1, 4, s61
    v_add_u32 v17, 114688, v16
    s_sub_u32 s60, s58, 28
    s_lshl_b32 s60, s60, 2
    s_add_u32 s60, s60, s56
    s_lshr_b32 s61, s57, 2
    s_lshr_b32 s62, s60, 2
    s_and_b32 s60, s60, 3
    s_mul_i32 s60, s60, 14
    v_bfe_u32 v4, v1, 2, 3
    v_mul_u32_u24 v4, 4, v4
    v_add_u32 v4, s62, v4
    v_min_u32 v4, 13, v4
    v_lshrrev_b32 v5, 5, v1
    v_mul_u32_u24 v5, 56, v5
    v_add3_u32 v4, v4, v5, s60
    v_lshl_add_u32 v4, v4, 1, s61
    v_and_b32 v5, 3, v1
    v_lshl_add_u32 v4, v4, 2, v5
    v_lshlrev_b32 v4, 7, v4
    v_add_u32 v4, 0x40000, v4
    v_lshrrev_b32 v5, 3, v1
    v_mul_u32_u24 v5, 114688, v5
    v_and_b32 v6, 7, v1
    v_lshl_add_u32 v5, v6, 7, v5
    s_mul_i32 s61, s61, 917504
    s_lshl_b32 s60, s60, 10
    s_add_u32 s63, s60, s61
    s_add_u32 s63, s63, 0x500000
    s_mov_b32 s3, s62
    s_mov_b32 s4, s63
    s_waitcnt vmcnt(0)
    s_mov_b64 exec, 1
    buffer_store_dword v3, off, s[48:51], s77 sc1
    s_mov_b64 exec, -1
    buffer_load_dword v132, v4, s[48:51], 0 offen sc1
    s_waitcnt vmcnt(0)
    s_mov_b32 s76, 262144
L_spw:
    v_cmp_ne_u32 vcc, s69, v132
    s_cbranch_vccz L_spw_ok
    buffer_load_dword v132, v4, s[48:51], 0 offen sc1
    s_sub_u32 s76, s76, 1
    s_waitcnt vmcnt(0)
    s_cbranch_scc0 L_spw
L_spw_ok:
    s_add_u32 s60, s3, 0
    s_min_u32 s60, s60, 13
    s_add_u32 s60, s60, 56
    s_lshl_b32 s60, s60, 10
    s_add_u32 s60, s60, s4
    buffer_load_dword v6, v5, s[48:51], s60 offen sc1
    s_add_u32 s60, s3, 4
    s_min_u32 s60, s60, 13
    s_add_u32 s60, s60, 56
    s_lshl_b32 s60, s60, 10
    s_add_u32 s60, s60, s4
    buffer_load_dword v6, v5, s[48:51], s60 offen sc1
    s_waitcnt vmcnt(1)
    s_add_u32 s60, s3, 8
    s_min_u32 s60, s60, 13
    s_add_u32 s60, s60, 56
    s_lshl_b32 s60, s60, 10
    s_add_u32 s60, s60, s4
    buffer_load_dword v6, v5, s[48:51], s60 offen sc1
    s_waitcnt vmcnt(1)
    s_add_u32 s60, s3, 12
    s_min_u32 s60, s60, 13
    s_add_u32 s60, s60, 56
    s_lshl_b32 s60, s60, 10
    s_add_u32 s60, s60, s4
    buffer_load_dword v6, v5, s[48:51], s60 offen sc1
    s_waitcnt vmcnt(1)
    s_add_u32 s60, s3, 0
    s_min_u32 s60, s60, 13
    s_add_u32 s60, s60, 0
    s_lshl_b32 s60, s60, 10
    s_add_u32 s60, s60, s4
    buffer_load_dword v6, v5, s[48:51], s60 offen sc1
    s_waitcnt vmcnt(1)
    s_add_u32 s60, s3, 4
    s_min_u32 s60, s60, 13
    s_add_u32 s60, s60, 0
    s_lshl_b32 s60, s60, 10
    s_add_u32 s60, s60, s4
    buffer_load_dword v6, v5, s[48:51], s60 offen sc1
    s_waitcnt vmcnt(1)
    s_add_u32 s60, s3, 8
    s_min_u32 s60, s60, 13
    s_add_u32 s60, s60, 0
    s_lshl_b32 s60, s60, 10
    s_add_u32 s60, s60, s4
    buffer_load_dword v6, v5, s[48:51], s60 offen sc1
    s_waitcnt vmcnt(1)
    s_add_u32 s60, s3, 12
    s_min_u32 s60, s60, 13
    s_add_u32 s60, s60, 0
    s_lshl_b32 s60, s60, 10
    s_add_u32 s60, s60, s4
    buffer_load_dword v6, v5, s[48:51], s60 offen sc1
    s_waitcnt vmcnt(1)
    s_waitcnt vmcnt(0)
L_spg:
    ds_read_b128 v[136:139], v55 offset:48
    s_waitcnt lgkmcnt(0)
    v_and_b32 v136, v136, v137
    v_and_b32 v136, v136, v138
    v_and_b32 v136, v136, v139
    v_cmp_eq_u32 vcc, 0, v136
    s_cbranch_vccnz L_spg
    s_lshl_b32 s60, s56, 2
    s_add_u32 s60, s60, 157184
    v_mov_b32 v3, s60
    v_mov_b32 v2, -1
    ds_write_b32 v3, v2 offset:48
    s_branch L_g_tail
L_spare_H:
    v_and_b32 v2, 1, v1
    v_lshlrev_b32 v2, 4, v2
    v_mov_b32 v3, 0x3f80
    v_lshlrev_b32 v2, v2, v3
    v_bfe_u32 v3, v1, 1, 4
    v_lshrrev_b32 v4, 5, v1
    v_lshlrev_b32 v4, 2, v4
    v_sub_u32 v4, v3, v4
    v_cmp_gt_u32 s[62:63], 32, v1
    v_cmp_eq_u32 vcc, 0, v4
    s_nop 1
    v_cndmask_b32 v240, 0, v2, vcc
    v_cmp_eq_u32 vcc, 8, v4
    s_nop 1
    v_cndmask_b32 v244, 0, v2, vcc
    v_cmp_eq_u32 vcc, 8, v3
    s_nop 1
    v_cndmask_b32 v5, 0, v2, vcc
    v_cndmask_b32 v248, 0, v5, s[62:63]
    v_cndmask_b32 v252, v5, 0, s[62:63]
    v_cmp_eq_u32 vcc, 1, v4
    s_nop 1
    v_cndmask_b32 v241, 0, v2, vcc
    v_cmp_eq_u32 vcc, 9, v4
    s_nop 1
    v_cndmask_b32 v245, 0, v2, vcc
    v_cmp_eq_u32 vcc, 9, v3
    s_nop 1
    v_cndmask_b32 v5, 0, v2, vcc
    v_cndmask_b32 v249, 0, v5, s[62:63]
    v_cndmask_b32 v253, v5, 0, s[62:63]
    v_cmp_eq_u32 vcc, 2, v4
    s_nop 1
    v_cndmask_b32 v242, 0, v2, vcc
    v_cmp_eq_u32 vcc, 10, v4
    s_nop 1
    v_cndmask_b32 v246, 0, v2, vcc
    v_cmp_eq_u32 vcc, 10, v3
    s_nop 1
    v_cndmask_b32 v5, 0, v2, vcc
    v_cndmask_b32 v250, 0, v5, s[62:63]
    v_cndmask_b32 v254, v5, 0, s[62:63]
    v_cmp_eq_u32 vcc, 3, v4
    s_nop 1
    v_cndmask_b32 v243, 0, v2, vcc
    v_cmp_eq_u32 vcc, 11, v4
    s_nop 1
    v_cndmask_b32 v247, 0, v2, vcc
    v_cmp_eq_u32 vcc, 11, v3
    s_nop 1
    v_cndmask_b32 v5, 0, v2, vcc
    v_cndmask_b32 v251, 0, v5, s[62:63]
    v_cndmask_b32 v255, v5, 0, s[62:63]
    s_waitcnt vmcnt(0)
    v_mov_b32 v3, s69
    s_mov_b64 exec, 1
    buffer_store_dword v3, off, s[48:51], s77 sc1
    s_mov_b64 exec, -1
    s_lshr_b32 s60, s56, 1
    s_lshl_b32 s60, s60, 4
    s_lshr_b32 s60, s72, s60
    s_lshl_b32 s60, s60, 16
    v_mov_b32 v44, 0x3fb8aa3b
    v_mul_f32 v44, s60, v44
    v_exp_f32 v44, v44
    s_nop 0
    v_cvt_pk_bf16_f32 v44, 0, v44
    v_lshlrev_b32 v24, 16, v24
    v_lshlrev_b32 v25, 16, v25
    v_lshlrev_b32 v26, 16, v26
    v_lshlrev_b32 v27, 16, v27
    v_lshlrev_b32 v28, 16, v28
    v_lshlrev_b32 v29, 16, v29
    v_pk_mul_f32 v[40:41], v[24:25], v[44:45] op_sel_hi:[1,0]
    v_pk_mul_f32 v[26:27], v[26:27], v[44:45] op_sel_hi:[1,0]
    v_mul_f32 v44, 0x4138aa3b, v40
    v_mul_f32 v45, 0x3fa2f983, v41
    v_mul_f32 v46, 0x3fb8aa3b, v40
    v_mul_f32 v47, 0x3e22f983, v41
    v_mul_f32 v48, 0x43b8aa3b, v40
    v_mul_f32 v49, 0x4222f983, v41
    v_fract_f32 v45, v45
    v_exp_f32 v44, v44
    v_fract_f32 v47, v47
    v_exp_f32 v46, v46
    v_fract_f32 v49, v49
    v_exp_f32 v48, v48
    v_cos_f32 v30, v45
    v_sin_f32 v31, v45
    v_cos_f32 v32, v47
    v_sin_f32 v33, v47
    v_cos_f32 v34, v49
    v_sin_f32 v35, v49
    v_pk_mul_f32 v[42:43], v[28:29], v[26:27] op_sel_hi:[1,0]
    v_pk_fma_f32 v[42:43], v[28:29], v[26:27], v[42:43] op_sel:[1,1,0] op_sel_hi:[0,1,1] neg_lo:[0,1,0]
    v_pk_mul_f32 v[30:31], v[30:31], v[44:45] op_sel_hi:[1,0]
    v_pk_mul_f32 v[32:33], v[32:33], v[46:47] op_sel_hi:[1,0]
    v_pk_mul_f32 v[34:35], v[34:35], v[48:49] op_sel_hi:[1,0]
    v_pk_mul_f32 v[36:37], v[30:31], v[30:31] op_sel_hi:[1,0]
    v_pk_mul_f32 v[38:39], v[32:33], v[32:33] op_sel_hi:[1,0]
    v_pk_fma_f32 v[36:37], v[30:31], v[30:31], v[36:37] op_sel:[1,1,0] op_sel_hi:[0,1,1] neg_lo:[0,1,0]
    v_pk_fma_f32 v[38:39], v[32:33], v[32:33], v[38:39] op_sel:[1,1,0] op_sel_hi:[0,1,1] neg_lo:[0,1,0]
    v_pk_mul_f32 v[118:119], v[30:31], v[36:37] op_sel_hi:[1,0]
    v_pk_mul_f32 v[176:177], v[42:43], v[32:33] op_sel_hi:[1,0]
    v_pk_mul_f32 v[178:179], v[42:43], v[38:39] op_sel_hi:[1,0]
    v_pk_fma_f32 v[118:119], v[30:31], v[36:37], v[118:119] op_sel:[1,1,0] op_sel_hi:[0,1,1] neg_lo:[0,1,0]
    v_pk_mul_f32 v[190:191], v[42:43], v[34:35] op_sel_hi:[1,0]
    v_pk_mul_f32 v[120:121], v[36:37], v[36:37] op_sel_hi:[1,0]
    v_pk_fma_f32 v[176:177], v[42:43], v[32:33], v[176:177] op_sel:[1,1,0] op_sel_hi:[0,1,1] neg_lo:[0,1,0]
    v_pk_mul_f32 v[122:123], v[118:119], v[36:37] op_sel_hi:[1,0]
    v_pk_fma_f32 v[178:179], v[42:43], v[38:39], v[178:179] op_sel:[1,1,0] op_sel_hi:[0,1,1] neg_lo:[0,1,0]
    v_pk_fma_f32 v[120:121], v[36:37], v[36:37], v[120:121] op_sel:[1,1,0] op_sel_hi:[0,1,1] neg_lo:[0,1,0]
    v_pk_fma_f32 v[190:191], v[42:43], v[34:35], v[190:191] op_sel:[1,1,0] op_sel_hi:[0,1,1] neg_lo:[0,1,0]
    v_pk_mul_f32 v[180:181], v[176:177], v[38:39] op_sel_hi:[1,0]
    v_pk_fma_f32 v[122:123], v[118:119], v[36:37], v[122:123] op_sel:[1,1,0] op_sel_hi:[0,1,1] neg_lo:[0,1,0]
    v_pk_mul_f32 v[182:183], v[178:179], v[38:39] op_sel_hi:[1,0]
    v_pk_mul_f32 v[124:125], v[120:121], v[36:37] op_sel_hi:[1,0]
    v_pk_mul_f32 v[198:199], v[190:191], v[34:35] op_sel_hi:[1,0]
    v_pk_mul_f32 v[126:127], v[122:123], v[36:37] op_sel_hi:[1,0]
    v_pk_mul_f32 v[192:193], v[178:179], v[34:35] op_sel_hi:[1,0]
    v_pk_fma_f32 v[124:125], v[120:121], v[36:37], v[124:125] op_sel:[1,1,0] op_sel_hi:[0,1,1] neg_lo:[0,1,0]
    v_pk_fma_f32 v[180:181], v[176:177], v[38:39], v[180:181] op_sel:[1,1,0] op_sel_hi:[0,1,1] neg_lo:[0,1,0]
    v_pk_fma_f32 v[182:183], v[178:179], v[38:39], v[182:183] op_sel:[1,1,0] op_sel_hi:[0,1,1] neg_lo:[0,1,0]
    v_pk_fma_f32 v[126:127], v[122:123], v[36:37], v[126:127] op_sel:[1,1,0] op_sel_hi:[0,1,1] neg_lo:[0,1,0]
    v_pk_fma_f32 v[198:199], v[190:191], v[34:35], v[198:199] op_sel:[1,1,0] op_sel_hi:[0,1,1] neg_lo:[0,1,0]
    v_pk_mul_f32 v[128:129], v[124:125], v[36:37] op_sel_hi:[1,0]
    v_pk_fma_f32 v[192:193], v[178:179], v[34:35], v[192:193] op_sel:[1,1,0] op_sel_hi:[0,1,1] neg_lo:[0,1,0]
    v_pk_mul_f32 v[130:131], v[126:127], v[36:37] op_sel_hi:[1,0]
    v_pk_mul_f32 v[184:185], v[180:181], v[38:39] op_sel_hi:[1,0]
    v_pk_fma_f32 v[128:129], v[124:125], v[36:37], v[128:129] op_sel:[1,1,0] op_sel_hi:[0,1,1] neg_lo:[0,1,0]
    v_pk_mul_f32 v[186:187], v[182:183], v[38:39] op_sel_hi:[1,0]
    v_pk_mul_f32 v[202:203], v[198:199], v[34:35] op_sel_hi:[1,0]
    v_pk_fma_f32 v[130:131], v[126:127], v[36:37], v[130:131] op_sel:[1,1,0] op_sel_hi:[0,1,1] neg_lo:[0,1,0]
    v_pk_mul_f32 v[194:195], v[182:183], v[34:35] op_sel_hi:[1,0]
    v_pk_mul_f32 v[132:133], v[128:129], v[36:37] op_sel_hi:[1,0]
    v_pk_fma_f32 v[184:185], v[180:181], v[38:39], v[184:185] op_sel:[1,1,0] op_sel_hi:[0,1,1] neg_lo:[0,1,0]
    v_pk_mul_f32 v[134:135], v[130:131], v[36:37] op_sel_hi:[1,0]
    v_pk_fma_f32 v[186:187], v[182:183], v[38:39], v[186:187] op_sel:[1,1,0] op_sel_hi:[0,1,1] neg_lo:[0,1,0]
    v_pk_fma_f32 v[132:133], v[128:129], v[36:37], v[132:133] op_sel:[1,1,0] op_sel_hi:[0,1,1] neg_lo:[0,1,0]
    v_pk_fma_f32 v[202:203], v[198:199], v[34:35], v[202:203] op_sel:[1,1,0] op_sel_hi:[0,1,1] neg_lo:[0,1,0]
    v_pk_fma_f32 v[194:195], v[182:183], v[34:35], v[194:195] op_sel:[1,1,0] op_sel_hi:[0,1,1] neg_lo:[0,1,0]
    v_pk_fma_f32 v[134:135], v[130:131], v[36:37], v[134:135] op_sel:[1,1,0] op_sel_hi:[0,1,1] neg_lo:[0,1,0]
    v_pk_mul_f32 v[188:189], v[184:185], v[38:39] op_sel_hi:[1,0]
    v_pk_mul_f32 v[136:137], v[132:133], v[36:37] op_sel_hi:[1,0]
    v_pk_mul_f32 v[196:197], v[186:187], v[34:35] op_sel_hi:[1,0]
    v_pk_mul_f32 v[138:139], v[134:135], v[36:37] op_sel_hi:[1,0]
    v_pk_mul_f32 v[206:207], v[202:203], v[34:35] op_sel_hi:[1,0]
    v_pk_fma_f32 v[136:137], v[132:133], v[36:37], v[136:137] op_sel:[1,1,0] op_sel_hi:[0,1,1] neg_lo:[0,1,0]
    v_pk_mul_f32 v[200:201], v[194:195], v[34:35] op_sel_hi:[1,0]
    v_pk_fma_f32 v[188:189], v[184:185], v[38:39], v[188:189] op_sel:[1,1,0] op_sel_hi:[0,1,1] neg_lo:[0,1,0]
    v_pk_fma_f32 v[138:139], v[134:135], v[36:37], v[138:139] op_sel:[1,1,0] op_sel_hi:[0,1,1] neg_lo:[0,1,0]
    v_pk_fma_f32 v[196:197], v[186:187], v[34:35], v[196:197] op_sel:[1,1,0] op_sel_hi:[0,1,1] neg_lo:[0,1,0]
    v_pk_mul_f32 v[140:141], v[136:137], v[36:37] op_sel_hi:[1,0]
    v_pk_fma_f32 v[206:207], v[202:203], v[34:35], v[206:207] op_sel:[1,1,0] op_sel_hi:[0,1,1] neg_lo:[0,1,0]
    v_pk_mul_f32 v[142:143], v[138:139], v[36:37] op_sel_hi:[1,0]
    v_pk_fma_f32 v[200:201], v[194:195], v[34:35], v[200:201] op_sel:[1,1,0] op_sel_hi:[0,1,1] neg_lo:[0,1,0]
    v_pk_fma_f32 v[140:141], v[136:137], v[36:37], v[140:141] op_sel:[1,1,0] op_sel_hi:[0,1,1] neg_lo:[0,1,0]
    v_pk_mul_f32 v[204:205], v[200:201], v[34:35] op_sel_hi:[1,0]
    v_pk_mul_f32 v[208:209], v[206:207], v[34:35] op_sel_hi:[1,0]
    v_pk_fma_f32 v[142:143], v[138:139], v[36:37], v[142:143] op_sel:[1,1,0] op_sel_hi:[0,1,1] neg_lo:[0,1,0]
    v_pk_fma_f32 v[204:205], v[200:201], v[34:35], v[204:205] op_sel:[1,1,0] op_sel_hi:[0,1,1] neg_lo:[0,1,0]
    v_pk_mul_f32 v[144:145], v[140:141], v[36:37] op_sel_hi:[1,0]
    v_pk_fma_f32 v[208:209], v[206:207], v[34:35], v[208:209] op_sel:[1,1,0] op_sel_hi:[0,1,1] neg_lo:[0,1,0]
    v_pk_mul_f32 v[146:147], v[142:143], v[36:37] op_sel_hi:[1,0]
    v_pk_mul_f32 v[210:211], v[208:209], v[34:35] op_sel_hi:[1,0]
    v_pk_fma_f32 v[144:145], v[140:141], v[36:37], v[144:145] op_sel:[1,1,0] op_sel_hi:[0,1,1] neg_lo:[0,1,0]
    v_pk_fma_f32 v[210:211], v[208:209], v[34:35], v[210:211] op_sel:[1,1,0] op_sel_hi:[0,1,1] neg_lo:[0,1,0]
    v_pk_fma_f32 v[146:147], v[142:143], v[36:37], v[146:147] op_sel:[1,1,0] op_sel_hi:[0,1,1] neg_lo:[0,1,0]
    v_cvt_pk_bf16_f32 v88, v42, v176
    v_cvt_pk_bf16_f32 v100, -v43, -v177
    v_pk_mul_f32 v[148:149], v[144:145], v[36:37] op_sel_hi:[1,0]
    v_cvt_pk_bf16_f32 v89, v178, v180
    v_pk_mul_f32 v[150:151], v[146:147], v[36:37] op_sel_hi:[1,0]
    v_cvt_pk_bf16_f32 v101, -v179, -v181
    v_pk_fma_f32 v[148:149], v[144:145], v[36:37], v[148:149] op_sel:[1,1,0] op_sel_hi:[0,1,1] neg_lo:[0,1,0]
    v_cvt_pk_bf16_f32 v90, v182, v184
    v_pk_fma_f32 v[150:151], v[146:147], v[36:37], v[150:151] op_sel:[1,1,0] op_sel_hi:[0,1,1] neg_lo:[0,1,0]
    v_cvt_pk_bf16_f32 v102, -v183, -v185
    v_pk_mul_f32 v[212:213], v[210:211], v[34:35] op_sel_hi:[1,0]
    v_pk_mul_f32 v[152:153], v[148:149], v[36:37] op_sel_hi:[1,0]
    v_pk_fma_f32 v[212:213], v[210:211], v[34:35], v[212:213] op_sel:[1,1,0] op_sel_hi:[0,1,1] neg_lo:[0,1,0]
    v_pk_mul_f32 v[154:155], v[150:151], v[36:37] op_sel_hi:[1,0]
    v_cvt_pk_bf16_f32 v91, v186, v188
    v_pk_fma_f32 v[152:153], v[148:149], v[36:37], v[152:153] op_sel:[1,1,0] op_sel_hi:[0,1,1] neg_lo:[0,1,0]
    v_cvt_pk_bf16_f32 v103, -v187, -v189
    v_pk_fma_f32 v[154:155], v[150:151], v[36:37], v[154:155] op_sel:[1,1,0] op_sel_hi:[0,1,1] neg_lo:[0,1,0]
    v_cvt_pk_bf16_f32 v92, v190, v192
    v_cvt_pk_bf16_f32 v104, -v191, -v193
    v_pk_mul_f32 v[156:157], v[152:153], v[36:37] op_sel_hi:[1,0]
    v_cvt_pk_bf16_f32 v93, v194, v196
    v_pk_mul_f32 v[158:159], v[154:155], v[36:37] op_sel_hi:[1,0]
    v_cvt_pk_bf16_f32 v105, -v195, -v197
    v_pk_fma_f32 v[156:157], v[152:153], v[36:37], v[156:157] op_sel:[1,1,0] op_sel_hi:[0,1,1] neg_lo:[0,1,0]
    v_pk_mul_f32 v[214:215], v[212:213], v[34:35] op_sel_hi:[1,0]
    v_pk_fma_f32 v[158:159], v[154:155], v[36:37], v[158:159] op_sel:[1,1,0] op_sel_hi:[0,1,1] neg_lo:[0,1,0]
    v_pk_fma_f32 v[214:215], v[212:213], v[34:35], v[214:215] op_sel:[1,1,0] op_sel_hi:[0,1,1] neg_lo:[0,1,0]
    v_cvt_pk_bf16_f32 v94, v198, v200
    v_pk_mul_f32 v[160:161], v[156:157], v[36:37] op_sel_hi:[1,0]
    v_cvt_pk_bf16_f32 v106, -v199, -v201
    v_pk_mul_f32 v[162:163], v[158:159], v[36:37] op_sel_hi:[1,0]
    v_cvt_pk_bf16_f32 v95, v202, v204
    v_pk_fma_f32 v[160:161], v[156:157], v[36:37], v[160:161] op_sel:[1,1,0] op_sel_hi:[0,1,1] neg_lo:[0,1,0]
    v_cvt_pk_bf16_f32 v107, -v203, -v205
    v_pk_fma_f32 v[162:163], v[158:159], v[36:37], v[162:163] op_sel:[1,1,0] op_sel_hi:[0,1,1] neg_lo:[0,1,0]
    v_cvt_pk_bf16_f32 v96, v206, v208
    v_cvt_pk_bf16_f32 v108, -v207, -v209
    v_pk_mul_f32 v[164:165], v[160:161], v[36:37] op_sel_hi:[1,0]
    v_mov_b32 v99, 0
    v_pk_mul_f32 v[166:167], v[162:163], v[36:37] op_sel_hi:[1,0]
    v_mov_b32 v111, 0
    v_pk_fma_f32 v[164:165], v[160:161], v[36:37], v[164:165] op_sel:[1,1,0] op_sel_hi:[0,1,1] neg_lo:[0,1,0]
    v_permlane32_swap_b32 v88, v92
    v_pk_fma_f32 v[166:167], v[162:163], v[36:37], v[166:167] op_sel:[1,1,0] op_sel_hi:[0,1,1] neg_lo:[0,1,0]
    v_permlane32_swap_b32 v89, v93
    v_permlane32_swap_b32 v90, v94
    v_pk_mul_f32 v[168:169], v[164:165], v[36:37] op_sel_hi:[1,0]
    v_permlane32_swap_b32 v91, v95
    v_pk_mul_f32 v[170:171], v[166:167], v[36:37] op_sel_hi:[1,0]
    v_cvt_pk_bf16_f32 v97, v210, v212
    v_pk_fma_f32 v[168:169], v[164:165], v[36:37], v[168:169] op_sel:[1,1,0] op_sel_hi:[0,1,1] neg_lo:[0,1,0]
    v_cvt_pk_bf16_f32 v109, -v211, -v213
    v_pk_fma_f32 v[170:171], v[166:167], v[36:37], v[170:171] op_sel:[1,1,0] op_sel_hi:[0,1,1] neg_lo:[0,1,0]
    v_cvt_pk_bf16_f32 v98, v214, v214
    v_cvt_pk_bf16_f32 v110, -v215, -v215
    v_pk_mul_f32 v[172:173], v[168:169], v[36:37] op_sel_hi:[1,0]
    v_permlane32_swap_b32 v100, v104
    v_pk_mul_f32 v[174:175], v[170:171], v[36:37] op_sel_hi:[1,0]
    v_permlane32_swap_b32 v101, v105
    v_pk_fma_f32 v[172:173], v[168:169], v[36:37], v[172:173] op_sel:[1,1,0] op_sel_hi:[0,1,1] neg_lo:[0,1,0]
    v_permlane32_swap_b32 v102, v106
    v_pk_fma_f32 v[174:175], v[170:171], v[36:37], v[174:175] op_sel:[1,1,0] op_sel_hi:[0,1,1] neg_lo:[0,1,0]
    v_permlane32_swap_b32 v103, v107
    v_mfma_f32_32x32x16_bf16 v[176:191], v[88:91], v[240:243], 0
    v_cvt_pk_bf16_f32 v56, 1.0, v30
    v_cvt_pk_bf16_f32 v57, v36, v118
    v_cvt_pk_bf16_f32 v58, v120, v122
    v_cvt_pk_bf16_f32 v59, v124, v126
    v_cvt_pk_bf16_f32 v60, v128, v130
    v_cvt_pk_bf16_f32 v61, v132, v134
    v_mfma_f32_32x32x16_bf16 v[192:207], v[92:95], v[240:243], 0
    v_cvt_pk_bf16_f32 v62, v136, v138
    v_cvt_pk_bf16_f32 v63, v140, v142
    v_cvt_pk_bf16_f32 v72, 0, v31
    v_cvt_pk_bf16_f32 v73, v37, v119
    v_cvt_pk_bf16_f32 v74, v121, v123
    v_cvt_pk_bf16_f32 v75, v125, v127
    v_mfma_f32_32x32x16_bf16 v[208:223], v[100:103], v[240:243], 0
    v_cvt_pk_bf16_f32 v76, v129, v131
    v_cvt_pk_bf16_f32 v77, v133, v135
    v_cvt_pk_bf16_f32 v78, v137, v139
    v_cvt_pk_bf16_f32 v79, v141, v143
    v_permlane32_swap_b32 v56, v60
    v_permlane32_swap_b32 v57, v61
    v_mfma_f32_32x32x16_bf16 v[224:239], v[104:107], v[240:243], 0
    v_permlane32_swap_b32 v58, v62
    v_permlane32_swap_b32 v59, v63
    v_permlane32_swap_b32 v72, v76
    v_permlane32_swap_b32 v73, v77
    v_permlane32_swap_b32 v74, v78
    v_permlane32_swap_b32 v75, v79
    v_mfma_f32_32x32x16_bf16 v[176:191], v[96:99], v[248:251], v[176:191]
    v_cvt_pk_bf16_f32 v64, v144, v146
    v_cvt_pk_bf16_f32 v65, v148, v150
    v_cvt_pk_bf16_f32 v66, v152, v154
    v_cvt_pk_bf16_f32 v67, v156, v158
    v_cvt_pk_bf16_f32 v68, v160, v162
    v_cvt_pk_bf16_f32 v69, v164, v166
    v_mfma_f32_32x32x16_bf16 v[192:207], v[96:99], v[252:255], v[192:207]
    v_cvt_pk_bf16_f32 v70, v168, v170
    v_cvt_pk_bf16_f32 v71, v172, v174
    v_cvt_pk_bf16_f32 v80, v145, v147
    v_cvt_pk_bf16_f32 v81, v149, v151
    v_cvt_pk_bf16_f32 v82, v153, v155
    v_cvt_pk_bf16_f32 v83, v157, v159
    v_mfma_f32_32x32x16_bf16 v[208:223], v[108:111], v[248:251], v[208:223]
    v_cvt_pk_bf16_f32 v84, v161, v163
    v_cvt_pk_bf16_f32 v85, v165, v167
    v_cvt_pk_bf16_f32 v86, v169, v171
    v_cvt_pk_bf16_f32 v87, v173, v175
    v_permlane32_swap_b32 v64, v68
    v_permlane32_swap_b32 v65, v69
    v_mfma_f32_32x32x16_bf16 v[224:239], v[108:111], v[252:255], v[224:239]
    v_permlane32_swap_b32 v66, v70
    v_permlane32_swap_b32 v67, v71
    v_permlane32_swap_b32 v80, v84
    v_permlane32_swap_b32 v81, v85
    v_permlane32_swap_b32 v82, v86
    v_permlane32_swap_b32 v83, v87
    v_mfma_f32_32x32x16_bf16 v[112:127], v[56:59], v[240:243], 0
    v_cvt_pk_bf16_f32 v176, v176, v177
    v_cvt_pk_bf16_f32 v177, v178, v179
    v_cvt_pk_bf16_f32 v178, v180, v181
    v_cvt_pk_bf16_f32 v179, v182, v183
    v_cvt_pk_bf16_f32 v180, v184, v185
    v_mfma_f32_32x32x16_bf16 v[112:127], v[64:67], v[244:247], v[112:127]
    v_cvt_pk_bf16_f32 v181, v186, v187
    v_cvt_pk_bf16_f32 v182, v188, v189
    v_cvt_pk_bf16_f32 v183, v190, v191
    v_cvt_pk_bf16_f32 v192, v192, v193
    v_cvt_pk_bf16_f32 v193, v194, v195
    v_mfma_f32_32x32x16_bf16 v[128:143], v[60:63], v[240:243], 0
    v_cvt_pk_bf16_f32 v194, v196, v197
    v_cvt_pk_bf16_f32 v195, v198, v199
    v_cvt_pk_bf16_f32 v196, v200, v201
    v_cvt_pk_bf16_f32 v197, v202, v203
    v_cvt_pk_bf16_f32 v198, v204, v205
    v_mfma_f32_32x32x16_bf16 v[128:143], v[68:71], v[244:247], v[128:143]
    v_cvt_pk_bf16_f32 v199, v206, v207
    v_cvt_pk_bf16_f32 v208, v208, v209
    v_cvt_pk_bf16_f32 v209, v210, v211
    v_cvt_pk_bf16_f32 v210, v212, v213
    v_cvt_pk_bf16_f32 v211, v214, v215
    v_mfma_f32_32x32x16_bf16 v[144:159], v[72:75], v[240:243], 0
    v_cvt_pk_bf16_f32 v212, v216, v217
    v_cvt_pk_bf16_f32 v213, v218, v219
    v_cvt_pk_bf16_f32 v214, v220, v221
    v_cvt_pk_bf16_f32 v215, v222, v223
    v_cvt_pk_bf16_f32 v224, v224, v225
    v_cvt_pk_bf16_f32 v225, v226, v227
    v_mfma_f32_32x32x16_bf16 v[144:159], v[80:83], v[244:247], v[144:159]
    v_cvt_pk_bf16_f32 v226, v228, v229
    v_cvt_pk_bf16_f32 v227, v230, v231
    v_cvt_pk_bf16_f32 v228, v232, v233
    v_cvt_pk_bf16_f32 v229, v234, v235
    v_cvt_pk_bf16_f32 v230, v236, v237
    v_cvt_pk_bf16_f32 v231, v238, v239
    v_mfma_f32_32x32x16_bf16 v[160:175], v[76:79], v[240:243], 0
    v_cvt_pk_bf16_f32 v112, v112, v113
    v_cvt_pk_bf16_f32 v113, v114, v115
    v_cvt_pk_bf16_f32 v114, v116, v117
    v_cvt_pk_bf16_f32 v115, v118, v119
    v_cvt_pk_bf16_f32 v116, v120, v121
    v_cvt_pk_bf16_f32 v117, v122, v123
    v_mfma_f32_32x32x16_bf16 v[160:175], v[84:87], v[244:247], v[160:175]
    v_cvt_pk_bf16_f32 v118, v124, v125
    v_cvt_pk_bf16_f32 v119, v126, v127
    v_cvt_pk_bf16_f32 v128, v128, v129
    v_cvt_pk_bf16_f32 v129, v130, v131
    v_cvt_pk_bf16_f32 v130, v132, v133
    v_cvt_pk_bf16_f32 v131, v134, v135
    v_mfma_f32_32x32x16_bf16 v[56:71], v[176:179], v[112:115], 0
    v_cvt_pk_bf16_f32 v132, v136, v137
    v_cvt_pk_bf16_f32 v133, v138, v139
    v_cvt_pk_bf16_f32 v134, v140, v141
    v_cvt_pk_bf16_f32 v135, v142, v143
    v_mfma_f32_32x32x16_bf16 v[56:71], v[180:183], v[116:119], v[56:71]
    v_cvt_pk_bf16_f32 v144, v144, v145
    v_cvt_pk_bf16_f32 v145, v146, v147
    v_cvt_pk_bf16_f32 v146, v148, v149
    v_cvt_pk_bf16_f32 v147, v150, v151
    v_mfma_f32_32x32x16_bf16 v[56:71], v[192:195], v[128:131], v[56:71]
    v_cvt_pk_bf16_f32 v148, v152, v153
    v_cvt_pk_bf16_f32 v149, v154, v155
    v_cvt_pk_bf16_f32 v150, v156, v157
    v_cvt_pk_bf16_f32 v151, v158, v159
    v_mfma_f32_32x32x16_bf16 v[56:71], v[196:199], v[132:135], v[56:71]
    v_cvt_pk_bf16_f32 v160, v160, v161
    v_cvt_pk_bf16_f32 v161, v162, v163
    v_cvt_pk_bf16_f32 v162, v164, v165
    v_cvt_pk_bf16_f32 v163, v166, v167
    v_mfma_f32_32x32x16_bf16 v[56:71], v[208:211], v[144:147], v[56:71]
    v_cvt_pk_bf16_f32 v164, v168, v169
    v_cvt_pk_bf16_f32 v165, v170, v171
    v_cvt_pk_bf16_f32 v166, v172, v173
    v_cvt_pk_bf16_f32 v167, v174, v175
    v_mfma_f32_32x32x16_bf16 v[56:71], v[212:215], v[148:151], v[56:71]
    v_mfma_f32_32x32x16_bf16 v[56:71], v[224:227], v[160:163], v[56:71]
    v_mfma_f32_32x32x16_bf16 v[56:71], v[228:231], v[164:167], v[56:71]
    s_lshr_b32 s60, s56, 1
    s_lshl_b32 s60, s60, 13
    s_add_u32 s60, s60, 65536
    s_and_b32 s61, s56, 1
    s_mul_i32 s61, s61, 5120
    s_add_u32 s62, s60, s61
    v_lshl_add_u32 v20, v1, 4, s62
    s_sub_u32 s62, s60, s61
    s_add_u32 s62, s62, 5120
    v_lshl_add_u32 v21, v1, 4, s62
    s_add_u32 s77, s60, 3072
    s_nop 0
    ds_write_b128 v20, v[56:59] offset:0
    ds_write_b128 v20, v[60:63] offset:1024
    ds_write_b128 v20, v[64:67] offset:2048
    v_lshlrev_b32 v144, 3, v0
    v_cvt_f32_u32 v144, v144
    v_lshlrev_b32 v156, 4, v0
    v_add_f32 v145, 0x3f800000, v144
    v_add_f32 v146, 0x40000000, v144
    v_add_f32 v147, 0x40400000, v144
    v_add_f32 v148, 0x40800000, v144
    v_add_f32 v149, 0x40a00000, v144
    v_add_f32 v150, 0x40c00000, v144
    v_add_f32 v151, 0x40e00000, v144
    v_add_f32 v152, 0x41000000, v144
    v_add_f32 v153, 0x41100000, v144
    v_add_f32 v154, 0x41200000, v144
    v_add_f32 v155, 0x41300000, v144
    v_cvt_pk_bf16_f32 v144, v144, v145
    v_cvt_pk_bf16_f32 v146, v146, v147
    v_cvt_pk_bf16_f32 v148, v148, v149
    v_cvt_pk_bf16_f32 v150, v150, v151
    v_cvt_pk_bf16_f32 v152, v152, v153
    v_cvt_pk_bf16_f32 v154, v154, v155
    v_cmp_gt_u32 s[26:27], 16, v0
    v_lshlrev_b32_sdwa v24, 1, v144 dst_sel:DWORD dst_unused:UNUSED_PAD src0_sel:DWORD src1_sel:WORD_0
    v_add_u32 v145, 34048, v156
    v_cndmask_b32 v24, v24, v145, s[26:27]
    v_lshlrev_b32_sdwa v25, 1, v144 dst_sel:DWORD dst_unused:UNUSED_PAD src0_sel:DWORD src1_sel:WORD_1
    v_add_u32 v145, 34050, v156
    v_cndmask_b32 v25, v25, v145, s[26:27]
    v_lshlrev_b32_sdwa v26, 1, v146 dst_sel:DWORD dst_unused:UNUSED_PAD src0_sel:DWORD src1_sel:WORD_0
    v_add_u32 v145, 34052, v156
    v_cndmask_b32 v26, v26, v145, s[26:27]
    v_lshlrev_b32_sdwa v27, 1, v146 dst_sel:DWORD dst_unused:UNUSED_PAD src0_sel:DWORD src1_sel:WORD_1
    v_add_u32 v145, 34054, v156
    v_cndmask_b32 v27, v27, v145, s[26:27]
    v_lshlrev_b32_sdwa v28, 1, v148 dst_sel:DWORD dst_unused:UNUSED_PAD src0_sel:DWORD src1_sel:WORD_0
    v_add_u32 v145, 34056, v156
    v_cndmask_b32 v28, v28, v145, s[26:27]
    v_lshlrev_b32_sdwa v29, 1, v148 dst_sel:DWORD dst_unused:UNUSED_PAD src0_sel:DWORD src1_sel:WORD_1
    v_add_u32 v145, 34058, v156
    v_cndmask_b32 v29, v29, v145, s[26:27]
    v_lshlrev_b32_sdwa v30, 1, v150 dst_sel:DWORD dst_unused:UNUSED_PAD src0_sel:DWORD src1_sel:WORD_0
    v_add_u32 v145, 34060, v156
    v_cndmask_b32 v30, v30, v145, s[26:27]
    v_lshlrev_b32_sdwa v31, 1, v150 dst_sel:DWORD dst_unused:UNUSED_PAD src0_sel:DWORD src1_sel:WORD_1
    v_add_u32 v145, 34062, v156
    v_cndmask_b32 v31, v31, v145, s[26:27]
    v_lshlrev_b32_sdwa v32, 1, v152 dst_sel:DWORD dst_unused:UNUSED_PAD src0_sel:DWORD src1_sel:WORD_0
    v_add_u32 v145, 34064, v156
    v_cndmask_b32 v32, v32, v145, s[26:27]
    v_lshlrev_b32_sdwa v33, 1, v152 dst_sel:DWORD dst_unused:UNUSED_PAD src0_sel:DWORD src1_sel:WORD_1
    v_add_u32 v145, 34066, v156
    v_cndmask_b32 v33, v33, v145, s[26:27]
    v_lshlrev_b32_sdwa v34, 1, v154 dst_sel:DWORD dst_unused:UNUSED_PAD src0_sel:DWORD src1_sel:WORD_0
    v_add_u32 v145, 34068, v156
    v_cndmask_b32 v34, v34, v145, s[26:27]
    v_add_u32 v35, 114720, v156
    s_waitcnt lgkmcnt(0)
    v_mov_b32 v2, -1
    ds_write_b32 v54, v2 offset:0
L_sps0:
    ds_read_b128 v[136:139], v55 offset:0
    s_waitcnt lgkmcnt(0)
    v_and_b32 v136, v136, v137
    v_and_b32 v136, v136, v138
    v_and_b32 v136, v136, v139
    v_cmp_eq_u32 vcc, 0, v136
    s_cbranch_vccnz L_sps0
    ds_read_b128 v[112:115], v21 offset:0
    ds_read_b128 v[116:119], v21 offset:1024
    ds_read_b128 v[120:123], v21 offset:2048
    v_and_b32 v44, 31, v1
    v_lshrrev_b32 v45, 5, v1
    v_lshlrev_b32 v46, 3, v45
    v_lshl_add_u32 v46, v44, 4, v46
    v_add_u32 v46, s77, v46
    v_cmp_gt_u32 vcc, 32, v1
    v_lshlrev_b32 v47, 3, v44
    v_add_u32 v47, 512, v47
    v_lshlrev_b32 v48, 2, v44
    v_add_u32 v48, 768, v48
    v_cndmask_b32 v47, v48, v47, vcc
    v_add_u32 v47, s77, v47
    v_mov_b32 v48, 128
    v_cndmask_b32 v48, v48, 4, vcc
    v_add_u32 v48, v48, v47
    v_lshlrev_b32 v49, 8, v45
    v_lshl_add_u32 v49, v44, 1, v49
    v_add_u32 v49, s77, v49
    s_waitcnt lgkmcnt(0)
    v_add_f32 v56, v56, v112
    v_add_f32 v57, v57, v113
    v_add_f32 v58, v58, v114
    v_add_f32 v59, v59, v115
    v_add_f32 v60, v60, v116
    v_add_f32 v61, v61, v117
    v_add_f32 v62, v62, v118
    v_add_f32 v63, v63, v119
    v_add_f32 v64, v64, v120
    v_add_f32 v65, v65, v121
    v_add_f32 v66, v66, v122
    v_add_f32 v67, v67, v123
    v_cvt_pk_bf16_f32 v112, v56, v57
    v_cvt_pk_bf16_f32 v113, v58, v59
    v_cvt_pk_bf16_f32 v114, v60, v61
    v_cvt_pk_bf16_f32 v115, v62, v63
    v_cvt_pk_bf16_f32 v116, v64, v64
    v_cvt_pk_bf16_f32 v117, v65, v65
    v_cvt_pk_bf16_f32 v118, v66, v66
    v_cvt_pk_bf16_f32 v119, v67, v67
    ds_write_b64 v46, v[112:113]
    ds_write_b32 v47, v114
    ds_write_b32 v48, v115
    ds_write_b16 v49, v116 offset:1024
    ds_write_b16 v49, v117 offset:1088
    ds_write_b16 v49, v118 offset:1152
    ds_write_b16 v49, v119 offset:1216
    s_and_b32 s60, s57, 1
    s_lshl_b32 s60, s60, 2
    s_and_b32 s61, s58, 3
    s_add_u32 s64, s60, s61
    s_lshr_b32 s60, s57, 1
    s_mul_i32 s60, s60, 7
    s_lshr_b32 s61, s58, 2
    s_add_u32 s65, s60, s61
    s_and_b32 s60, s57, 1
    s_lshl_b32 s60, s60, 4
    s_and_b32 s61, s57, 2
    s_lshl_b32 s61, s61, 2
    s_add_u32 s60, s60, s61
    s_lshr_b32 s78, s58, 2
    s_add_u32 s73, s60, s78
    s_and_b32 s60, s57, 4
    s_and_b32 s61, s58, 3
    s_add_u32 s74, s60, s61
    s_mov_b32 s89, 0
    s_mov_b32 s90, 2048
    s_mov_b32 s91, 4096
    s_mov_b32 s92, 6144
    s_mov_b32 s93, 8192
    s_mov_b32 s94, 10240
    s_mov_b32 s95, 12288
    s_lshl_b32 s60, s56, 6
    s_add_u32 s60, s60, s57
    s_lshl_b32 s60, s60, 4
    s_add_u32 s60, s60, 0x1000
    v_and_b32 v20, 7, v1
    v_lshl_add_u32 v20, v20, 7, s60
    v_and_b32 v21, 31, v1
    s_lshl_b32 s60, s64, 5
    v_add_u32 v21, s60, v21
    v_and_b32 v2, 7, v1
    s_lshl_b32 s60, s73, 3
    v_add_u32 v2, s60, v2
    v_cmp_gt_u32 vcc, 32, v1
    s_nop 1
    v_cndmask_b32 v21, v2, v21, vcc
    v_lshlrev_b32 v21, 4, v21
    v_add_u32 v21, 0x1000, v21
    v_and_b32 v23, 15, v1
    v_min_u32 v23, 13, v23
    v_bfe_u32 v2, v1, 4, 1
    v_mul_u32_u24 v2, 56, v2
    v_sub_u32 v23, v23, v2
    s_mul_i32 s60, s59, 14
    v_add_u32 v23, s60, v23
    v_lshlrev_b32 v23, 10, v23
    s_lshl_b32 s60, s74, 7
    s_add_u32 s60, s60, 0x40000
    v_add_u32 v23, s60, v23
    buffer_load_dword v22, v21, s[48:51], 0 offen sc1
    buffer_load_dword v132, v23, s[48:51], 0 offen sc1
    buffer_load_dword v133, v20, s[48:51], 0 offen sc1
    s_waitcnt lgkmcnt(0)
    v_mov_b32 v2, -1
    ds_write_b32 v54, v2 offset:16
L_sps1:
    ds_read_b128 v[136:139], v55 offset:16
    s_waitcnt lgkmcnt(0)
    v_and_b32 v136, v136, v137
    v_and_b32 v136, v136, v138
    v_and_b32 v136, v136, v139
    v_cmp_eq_u32 vcc, 0, v136
    s_cbranch_vccnz L_sps1
    ds_read_u16 v36, v24 offset:34560
    ds_read_u16 v37, v25 offset:34560
    ds_read_u16 v38, v26 offset:34560
    ds_read_u16 v39, v27 offset:34560
    ds_read_u16 v40, v28 offset:34560
    ds_read_u16 v41, v29 offset:34560
    ds_read_u16 v42, v30 offset:34560
    ds_read_u16 v43, v31 offset:34560
    ds_read_u16 v44, v32 offset:34560
    ds_read_u16 v45, v33 offset:34560
    ds_read_u16 v46, v34 offset:34560
    ds_read_u16 v112, v24 offset:42752
    ds_read_u16 v113, v25 offset:42752
    ds_read_u16 v114, v26 offset:42752
    ds_read_u16 v115, v27 offset:42752
    ds_read_u16 v116, v28 offset:42752
    ds_read_u16 v117, v29 offset:42752
    ds_read_u16 v118, v30 offset:42752
    ds_read_u16 v119, v31 offset:42752
    ds_read_u16 v120, v32 offset:42752
    ds_read_u16 v121, v33 offset:42752
    ds_read_u16 v122, v34 offset:42752
    v_bfe_u32 v2, v1, 3, 1
    v_lshlrev_b32 v3, 13, v2
    v_add_u32 v3, 68608, v3
    ds_read_b64 v[126:127], v3
    v_mul_u32_u24 v2, 16640, v2
    v_and_b32 v3, 3, v1
    v_mul_u32_u24 v4, 4160, v3
    v_add_u32 v2, v2, v4
    v_bfe_u32 v4, v1, 2, 1
    v_lshl_add_u32 v2, v4, 4, v2
    v_add_u32 v123, 114688, v2
    v_mul_u32_u24 v4, v4, v3
    v_cmp_ne_u32 s[26:27], 0, v4
    v_lshlrev_b32 v3, 4, v3
    v_sub_u32 v5, 64, v3
    v_mov_b32 v124, 0
    v_mov_b32 v125, 0
    s_waitcnt lgkmcnt(12)
    v_lshl_or_b32 v64, v37, 16, v36
    v_lshl_or_b32 v70, v38, 16, v37
    v_lshl_or_b32 v65, v39, 16, v38
    v_lshl_or_b32 v71, v40, 16, v39
    v_lshl_or_b32 v66, v41, 16, v40
    v_lshl_or_b32 v72, v42, 16, v41
    v_lshl_or_b32 v67, v43, 16, v42
    v_lshl_or_b32 v73, v44, 16, v43
    v_lshl_or_b32 v74, v39, 16, v38
    v_lshl_or_b32 v78, v40, 16, v39
    v_lshl_or_b32 v75, v41, 16, v40
    v_lshl_or_b32 v79, v42, 16, v41
    v_lshl_or_b32 v76, v43, 16, v42
    v_lshl_or_b32 v80, v44, 16, v43
    v_lshl_or_b32 v77, v45, 16, v44
    v_lshl_or_b32 v81, v46, 16, v45
    s_waitcnt lgkmcnt(1)
    v_lshl_or_b32 v84, v113, 16, v112
    v_lshl_or_b32 v90, v114, 16, v113
    v_lshl_or_b32 v85, v115, 16, v114
    v_lshl_or_b32 v91, v116, 16, v115
    v_lshl_or_b32 v86, v117, 16, v116
    v_lshl_or_b32 v92, v118, 16, v117
    v_lshl_or_b32 v87, v119, 16, v118
    v_lshl_or_b32 v93, v120, 16, v119
    v_lshl_or_b32 v94, v115, 16, v114
    v_lshl_or_b32 v98, v116, 16, v115
    v_lshl_or_b32 v95, v117, 16, v116
    v_lshl_or_b32 v99, v118, 16, v117
    v_lshl_or_b32 v96, v119, 16, v118
    v_lshl_or_b32 v100, v120, 16, v119
    v_lshl_or_b32 v97, v121, 16, v120
    v_lshl_or_b32 v101, v122, 16, v121
    s_waitcnt lgkmcnt(0)
    v_lshlrev_b64 v[126:127], v5, v[126:127]
    v_cndmask_b32 v126, 0, v126, s[26:27]
    v_cndmask_b32 v127, 0, v127, s[26:27]
    v_and_b32 v2, 15, v1
    v_lshrrev_b32 v3, 4, v1
    v_add_u32 v4, 1, v2
    v_and_b32 v5, 3, v4
    v_mul_u32_u24 v5, 4160, v5
    v_lshrrev_b32 v4, 2, v4
    v_lshl_add_u32 v5, v4, 3, v5
    v_lshl_add_u32 v5, v3, 4, v5
    s_lshr_b32 s60, s56, 1
    s_and_b32 s61, s56, 1
    s_lshl_b32 s61, s61, 8
    s_mul_i32 s62, s60, 16640
    s_add_u32 s62, s62, s61
    s_add_u32 s62, s62, 114688
    v_add_u32 v128, s62, v5
    v_lshlrev_b32 v4, 5, v2
    v_lshlrev_b32 v5, 4, v3
    v_sub_u32 v4, v4, v5
    s_mul_i32 s62, s60, 4608
    s_sub_u32 s62, s62, s61
    s_add_u32 s62, s62, 148304
    v_add_u32 v129, s62, v4
    v_lshl_add_u32 v27, v2, 6, v5
    s_lshl_b32 s60, s56, 13
    v_lshl_add_u32 v130, v1, 4, s60
    s_lshl_b32 s60, s56, 11
    v_lshl_add_u32 v131, v1, 4, s60
    s_mul_i32 s60, s59, 14
    s_mul_i32 s61, s73, 224
    s_add_u32 s61, s61, s60
    s_lshl_b32 s61, s61, 10
    s_add_u32 s61, s61, 0x700000
    v_lshl_add_u32 v18, v1, 4, s61
    v_add_u32 v19, 114688, v18
    s_mul_i32 s60, s59, 14
    s_mul_i32 s61, s74, 224
    s_add_u32 s61, s61, s60
    s_lshl_b32 s61, s61, 10
    s_add_u32 s61, s61, 0x500000
    v_lshl_add_u32 v16, v1, 4, s61
    v_add_u32 v17, 114688, v16
    s_waitcnt vmcnt(0)
    s_mov_b32 s76, 262144
L_sp:
    v_cmp_ne_u32 vcc, s69, v22
    v_cmp_ne_u32 s[62:63], s69, v132
    s_or_b64 vcc, vcc, s[62:63]
    v_cmp_ne_u32 s[62:63], s69, v133
    s_or_b64 vcc, vcc, s[62:63]
    s_cbranch_vccz L_sp_ok
    buffer_load_dword v22, v21, s[48:51], 0 offen sc1
    buffer_load_dword v132, v23, s[48:51], 0 offen sc1
    buffer_load_dword v133, v20, s[48:51], 0 offen sc1
    s_sub_u32 s76, s76, 1
    s_waitcnt vmcnt(0)
    s_cbranch_scc0 L_sp
L_sp_ok:
    s_waitcnt lgkmcnt(0)
    v_mov_b32 v2, -1
    ds_write_b32 v54, v2 offset:32
L_sps2:
    ds_read_b128 v[136:139], v55 offset:32
    s_waitcnt lgkmcnt(0)
    v_and_b32 v136, v136, v137
    v_and_b32 v136, v136, v138
    v_and_b32 v136, v136, v139
    v_cmp_eq_u32 vcc, 0, v136
    s_cbranch_vccnz L_sps2
    v_lshrrev_b32 v2, 4, v1
    v_and_b32 v3, 15, v1
    v_lshlrev_b32 v4, 16, v2
    v_lshl_add_u32 v4, v3, 4, v4
    s_lshl_b32 s60, s71, 8
    s_lshl_b32 s61, s56, 19
    s_add_u32 s60, s60, s61
    s_add_u32 s60, s60, 0x100000
    s_add_u32 s61, s60, 0x40000
    buffer_load_dwordx4 v[104:107], v4, s[48:51], s60 offen sc1
    buffer_load_dwordx4 v[108:111], v4, s[48:51], s61 offen sc1
    v_bfe_u32 v3, v1, 3, 1
    v_mul_u32_u24 v3, 4608, v3
    v_lshl_add_u32 v3, v2, 7, v3
    v_and_b32 v2, 7, v1
    v_lshl_add_u32 v3, v2, 4, v3
    s_lshl_b32 s60, s56, 10
    s_add_u32 s60, s60, 148480
    v_add_u32 v47, s60, v3
    v_lshrrev_b32 v2, 7, v0
    v_mul_u32_u24 v2, 4608, v2
    v_and_b32 v3, 127, v0
    v_lshl_add_u32 v2, v3, 2, v2
    v_add_u32 v2, 147968, v2
    v_mov_b32 v3, 0
    v_lshlrev_b32 v4, 2, v1
    v_and_b32 v4, 124, v4
    v_add_u32 v4, 157184, v4
    ds_write_b32 v2, v3
    ds_write_b32 v4, v3
    ds_write_b128 v35, v[64:67] offset:0
    ds_write_b128 v35, v[70:73] offset:4160
    ds_write_b128 v35, v[74:77] offset:8320
    ds_write_b128 v35, v[78:81] offset:12480
    ds_write_b128 v35, v[84:87] offset:16640
    ds_write_b128 v35, v[90:93] offset:20800
    ds_write_b128 v35, v[94:97] offset:24960
    ds_write_b128 v35, v[98:101] offset:29120
    ds_write_b128 v123, v[124:127]
    s_waitcnt vmcnt(0)
    ds_write_b128 v47, v[104:107]
    ds_write_b128 v47, v[108:111] offset:512
    buffer_load_dwordx4 v[144:147], v16, s[48:51], s89 offen offset:0 sc1
    buffer_load_dwordx4 v[148:151], v17, s[48:51], s89 offen offset:0 sc1
    buffer_load_dwordx4 v[152:155], v16, s[48:51], s89 offen offset:1024 sc1
    buffer_load_dwordx4 v[156:159], v17, s[48:51], s89 offen offset:1024 sc1
    buffer_load_dwordx4 v[160:163], v16, s[48:51], s90 offen offset:0 sc1
    buffer_load_dwordx4 v[164:167], v17, s[48:51], s90 offen offset:0 sc1
    buffer_load_dwordx4 v[168:171], v16, s[48:51], s90 offen offset:1024 sc1
    buffer_load_dwordx4 v[172:175], v17, s[48:51], s90 offen offset:1024 sc1
    buffer_load_dwordx4 v[176:179], v16, s[48:51], s91 offen offset:0 sc1
    buffer_load_dwordx4 v[180:183], v17, s[48:51], s91 offen offset:0 sc1
    buffer_load_dwordx4 v[184:187], v16, s[48:51], s91 offen offset:1024 sc1
    buffer_load_dwordx4 v[188:191], v17, s[48:51], s91 offen offset:1024 sc1
    buffer_load_dwordx4 v[192:195], v16, s[48:51], s92 offen offset:0 sc1
    buffer_load_dwordx4 v[196:199], v17, s[48:51], s92 offen offset:0 sc1
    buffer_load_dwordx4 v[200:203], v16, s[48:51], s92 offen offset:1024 sc1
    buffer_load_dwordx4 v[204:207], v17, s[48:51], s92 offen offset:1024 sc1
    buffer_load_dwordx4 v[208:211], v16, s[48:51], s93 offen offset:0 sc1
    buffer_load_dwordx4 v[212:215], v17, s[48:51], s93 offen offset:0 sc1
    buffer_load_dwordx4 v[216:219], v16, s[48:51], s93 offen offset:1024 sc1
    buffer_load_dwordx4 v[220:223], v17, s[48:51], s93 offen offset:1024 sc1
    buffer_load_dwordx4 v[224:227], v16, s[48:51], s94 offen offset:0 sc1
    buffer_load_dwordx4 v[228:231], v17, s[48:51], s94 offen offset:0 sc1
    buffer_load_dwordx4 v[232:235], v16, s[48:51], s94 offen offset:1024 sc1
    buffer_load_dwordx4 v[236:239], v17, s[48:51], s94 offen offset:1024 sc1
    buffer_load_dwordx4 v[240:243], v16, s[48:51], s95 offen offset:0 sc1
    buffer_load_dwordx4 v[244:247], v17, s[48:51], s95 offen offset:0 sc1
    buffer_load_dwordx4 v[248:251], v16, s[48:51], s95 offen offset:1024 sc1
    buffer_load_dwordx4 v[252:255], v17, s[48:51], s95 offen offset:1024 sc1
    s_waitcnt lgkmcnt(0)
    v_mov_b32 v2, -1
    ds_write_b32 v54, v2 offset:48
L_sps3:
    ds_read_b128 v[136:139], v55 offset:48
    s_waitcnt lgkmcnt(0)
    v_and_b32 v136, v136, v137
    v_and_b32 v136, v136, v138
    v_and_b32 v136, v136, v139
    v_cmp_eq_u32 vcc, 0, v136
    s_cbranch_vccnz L_sps3
    s_branch L_conv
L_code_end:

.section .rodata,"a"
.p2align 6
.amdhsa_kernel parallel_sum__ssm_conv_s4__glu_gated_reglu__prompt_kernel
  .amdhsa_next_free_vgpr 256
  .amdhsa_next_free_sgpr 102
  .amdhsa_accum_offset 256
  .amdhsa_group_segment_fixed_size 0
  .amdhsa_kernarg_size 128
  .amdhsa_user_sgpr_count 2
  .amdhsa_user_sgpr_kernarg_segment_ptr 1
  .amdhsa_system_sgpr_workgroup_id_x 1
.end_amdhsa_kernel
```
